```python
import torch

def _softmax(x, axis=-1):
    return torch.softmax(x, dim=axis)
def _gelu(x):
    return torch.nn.functional.gelu(x, approximate="tanh")
def _silu(x):
    return torch.nn.functional.silu(x)
def _sigmoid(x):
    return torch.sigmoid(x)
def _layernorm(x, axis=-1, eps=1e-5):
    m = x.mean(dim=axis, keepdim=True)
    v = x.var(dim=axis, keepdim=True, unbiased=False)
    return (x - m) / torch.sqrt(v + eps)
def _scatter_add(tgt, idx, src, axis=0):
    return tgt.clone().index_add_(axis, idx, src)
def _segment_sum(src, seg, n):
    out = torch.zeros((n,) + src.shape[1:], dtype=src.dtype)
    return out.index_add_(0, seg, src)
def _pad(x, pw):
    flat = tuple(v for pair in reversed(pw) for v in pair)
    return torch.nn.functional.pad(x, flat)

kernel_name = 'standalone__glu_gated_glu__prompt'

def setup_inputs():

    _w = (lambda a: (lambda t: t.to(torch.bfloat16) if t.is_floating_point() else t)(torch.as_tensor(a)))
    B, S, D, F = 1, 2048, 448, 1792
    return {
        "x": _w((lambda *s: torch.randn(*s, dtype=torch.bfloat16) * 0.2)(B, S, D)),
        "w_gate": _w((lambda *s: torch.randn(*s, dtype=torch.bfloat16) * 0.2)(D, F)),
        "w_up": _w((lambda *s: torch.randn(*s, dtype=torch.bfloat16) * 0.05)(D, F)),
        "w_down": _w((lambda *s: torch.randn(*s, dtype=torch.bfloat16) * 0.05)(F, D)),
    }

def reference(x, w_gate, w_up, w_down):
    g = torch.einsum("bsd,df->bsf", x, w_gate)
    u = torch.einsum("bsd,df->bsf", x, w_up)
    h = _sigmoid(g) * u
    return torch.einsum("bsf,fd->bsd", h, w_down)
```

```asm
; @launch grid=(256,1,1) block=(512,1,1) lds=163840
.amdgcn_target "amdgcn-amd-amdhsa--gfx950"
.text
.globl standalone__glu_gated_glu__prompt_kernel
.p2align 8
.type standalone__glu_gated_glu__prompt_kernel,@function
standalone__glu_gated_glu__prompt_kernel:
    s_getpc_b64 s[60:61]
    s_cmp_ge_u32 s2, 256
    s_cbranch_scc1 L_end
    s_load_dwordx8 s[4:11], s[0:1], 0
    s_load_dwordx4 s[12:15], s[0:1], 32
    s_load_dwordx2 s[76:77], s[0:1], 48
    s_mov_b32 s62, 21800
    s_mov_b32 s63, 0x20000
    v_lshlrev_b32 v3, 7, v0
    buffer_load_dword v15, v3, s[60:63], 0 offen
    v_lshrrev_b32 v1, 6, v0
    v_and_b32 v2, 63, v0
    v_readfirstlane_b32 s40, v1
    s_and_b32 s41, s2, 7
    s_lshr_b32 s42, s2, 3
    s_cmp_ge_u32 s42, 28
    s_cbranch_scc1 L_pref
    s_lshr_b32 s43, s41, 1
    s_and_b32 s51, s41, 1
    s_and_b32 s52, s42, 3
    s_lshr_b32 s53, s42, 2
    s_lshl_b32 s47, s43, 2
    s_add_u32 s47, s47, s52
    s_mul_i32 s48, s51, 7
    s_add_u32 s48, s48, s53
    s_and_b32 s50, s40, 3
    s_lshr_b32 s57, s50, 1
    s_and_b32 s56, s50, 1
    s_lshl_b32 s69, s57, 13
    s_lshl_b32 s71, s56, 11
    s_add_u32 s69, s69, s71
    s_lshl_b32 s71, s57, 11
    s_xor_b32 s27, s69, s71
    s_mul_i32 s67, s52, 1
    s_add_u32 s67, s67, s53
    s_mul_hi_u32 s71, s67, 1431655766
    s_mul_i32 s71, s71, 3
    s_sub_u32 s67, s67, s71
    s_mul_i32 s67, s67, 2
    s_mul_i32 s71, s43, 0
    s_add_u32 s67, s67, s71
    s_mul_i32 s71, s51, 2
    s_add_u32 s67, s67, s71
    s_mul_hi_u32 s71, s67, 613566757
    s_mul_i32 s71, s71, 7
    s_sub_u32 s67, s67, s71

    s_lshl_b32 s79, s52, 1
    s_add_u32 s79, s79, s53
    s_cmp_ge_u32 s79, 7
    s_cselect_b32 s71, 7, 0
    s_sub_u32 s79, s79, s71
    s_cmp_gt_u32 s40, 3
    s_cbranch_scc1 L_c
    v_lshrrev_b32 v3, 3, v2
    v_and_b32 v4, 7, v2
    v_lshrrev_b32 v5, 4, v2
    v_xor_b32 v20, v4, v5
    v_mul_u32_u24 v22, 896, v3
    v_lshl_add_u32 v6, v20, 4, v22
    v_xor_b32 v21, 4, v20
    v_lshl_add_u32 v7, v21, 4, v22
    v_add_u32 v7, 6144, v7
    v_and_b32 v20, 1, v5
    v_lshlrev_b32 v20, 2, v20
    v_xor_b32 v20, v4, v20
    v_mul_u32_u24 v23, 3584, v3
    v_lshl_add_u32 v8, v20, 4, v23
    v_xor_b32 v21, 2, v20
    v_lshl_add_u32 v9, v21, 4, v23
    v_add_u32 v9, 27648, v9
    s_lshl_b32 s64, s47, 3
    s_lshl_b32 s71, s57, 2
    s_add_u32 s64, s64, s71
    s_add_u32 s64, s64, s56
    s_mul_i32 s64, s64, 14336
    s_lshl_b32 s65, s48, 8
    s_mul_i32 s71, s56, 57344
    s_add_u32 s65, s65, s71
    s_mov_b32 s18, 1835008
    s_mov_b32 s19, 0x20000
    s_mov_b32 s22, 1605632
    s_mov_b32 s23, 0x20000
    s_mov_b32 s24, s67
    s_cmp_eq_u32 s57, 0
    s_waitcnt lgkmcnt(0)
    s_mov_b32 s16, s4
    s_mov_b32 s17, s5
    s_cselect_b32 s20, s6, s8
    s_cselect_b32 s21, s7, s9
    s_mov_b32 m0, s69
    s_lshl_b32 s68, s67, 7
    s_add_u32 s68, s68, s64
    buffer_load_dwordx4 v6, s[16:19], s68 offen lds
    buffer_load_dwordx4 v7, s[16:19], s68 offen offset:1024 lds
    s_add_u32 m0, s69, 4096
    s_add_u32 s68, s68, 28672
    buffer_load_dwordx4 v6, s[16:19], s68 offen lds
    buffer_load_dwordx4 v7, s[16:19], s68 offen offset:1024 lds
    s_add_u32 m0, s69, 16384
    s_mul_i32 s68, s67, 229376
    s_add_u32 s68, s68, s65
    buffer_load_dwordx4 v8, s[20:23], s68 offen lds
    buffer_load_dwordx4 v9, s[20:23], s68 offen offset:1024 lds
    s_add_u32 m0, s69, 20480
    s_add_u32 s68, s68, 114688
    buffer_load_dwordx4 v8, s[20:23], s68 offen lds
    s_add_u32 s67, s67, 1
    s_cmp_eq_u32 s67, 7
    s_cselect_b32 s67, 0, s67
    buffer_load_dwordx4 v9, s[20:23], s68 offen offset:1024 lds
    s_add_u32 m0, s69, 32768
    s_lshl_b32 s68, s67, 7
    s_add_u32 s68, s68, s64
    buffer_load_dwordx4 v6, s[16:19], s68 offen lds
    buffer_load_dwordx4 v7, s[16:19], s68 offen offset:1024 lds
    s_add_u32 m0, s69, 36864
    s_add_u32 s68, s68, 28672
    buffer_load_dwordx4 v6, s[16:19], s68 offen lds
    buffer_load_dwordx4 v7, s[16:19], s68 offen offset:1024 lds
    s_add_u32 m0, s69, 49152
    s_mul_i32 s68, s67, 229376
    s_add_u32 s68, s68, s65
    buffer_load_dwordx4 v8, s[20:23], s68 offen lds
    buffer_load_dwordx4 v9, s[20:23], s68 offen offset:1024 lds
    s_mov_b32 s28, s10
    s_mov_b32 s29, s11
    s_mov_b32 s30, 1605632
    s_mov_b32 s31, 0x20000

    s_mov_b32 s32, s76
    s_mov_b32 s33, s77
    s_mov_b32 s34, 268435456
    s_mov_b32 s35, 0x20000

    s_mov_b32 s36, s14
    s_mov_b32 s37, s15
    s_mov_b32 s38, 256
    s_mov_b32 s39, 0x20000

    s_mov_b32 s60, s12
    s_mov_b32 s61, s13
    s_mov_b32 s62, 1835008
    s_mov_b32 s63, 0x20000
    v_lshlrev_b32 v20, 1, v5
    v_xor_b32 v20, v4, v20
    v_lshl_add_u32 v10, v20, 4, v22
    v_add_u32 v11, 6144, v10
    v_lshlrev_b32 v12, 4, v2

    s_lshl_b32 s55, s43, 3
    s_lshl_b32 s71, s51, 2
    s_add_u32 s55, s55, s71
    s_add_u32 s55, s55, s52
    s_lshl_b32 s58, s55, 1
    s_add_u32 s58, s58, s56
    s_mul_i32 s70, s58, 14
    s_add_u32 s70, s70, s57
    s_lshl_b32 s70, s70, 13
    s_lshl_b32 s71, s58, 1
    s_add_u32 s71, s71, s57
    s_lshl_b32 s71, s71, 8
    s_add_u32 s71, s71, 8388608
    s_add_u32 s72, s76, s71
    s_addc_u32 s73, s77, 0
    s_lshl_b32 s66, s57, 3
    s_add_u32 s66, s66, s56
    s_mul_i32 s66, s66, 14336
    s_lshl_b32 s71, s53, 7
    s_add_u32 s66, s66, s71
    s_mul_i32 s71, s70, 14
    s_sub_u32 s66, s66, s71

    s_lshl_b32 s25, s55, 1
    s_add_u32 s25, s25, s57
    s_mul_i32 s25, s25, 28672
    s_lshl_b32 s71, s53, 7
    s_add_u32 s25, s25, s71
    s_lshl_b32 s71, s56, 6
    s_add_u32 s25, s25, s71
    s_lshl_b32 s26, s57, 13
    s_or_b32 s71, s71, s26
    v_bfe_u32 v24, v2, 2, 2
    v_and_b32 v25, 3, v2
    v_lshlrev_b32 v25, 3, v25
    v_lshl_add_u32 v25, v24, 7, v25
    v_lshrrev_b32 v24, 1, v24
    v_lshl_add_u32 v24, v5, 1, v24
    v_and_b32 v24, 3, v24
    v_lshl_add_u32 v25, v24, 5, v25
    v_lshl_add_u32 v25, v5, 9, v25
    s_waitcnt vmcnt(14)
    v_xor_b32 v13, s71, v25
    v_add_u32 v14, 0x10000, v13
    v_add_u32 v15, 0x20000, v13
    v_xor_b32 v16, 32, v13
    v_xor_b32 v17, 32, v14
    v_xor_b32 v18, 32, v15
    v_add_u32 v19, s26, v12
    v_add_u32 v20, 0x10000, v19
    v_add_u32 v21, 0x20000, v19
    v_and_b32 v24, 15, v2
    v_mul_u32_u24 v24, 896, v24
    v_and_b32 v25, 1, v5
    v_lshl_add_u32 v24, v25, 5, v24
    v_lshrrev_b32 v25, 1, v5
    v_lshl_add_u32 v22, v25, 4, v24
    v_add_u32 v23, 14336, v22
    s_lshl_b32 s26, s50, 12
    s_lshl_b32 s44, s79, 14
    s_add_u32 s44, s44, s70
    s_add_u32 s79, s79, 1
    s_cmp_eq_u32 s79, 7
    s_cselect_b32 s79, 0, s79
    s_lshl_b32 s45, s79, 14
    s_add_u32 s45, s45, s70
    s_add_u32 s79, s79, 1
    s_cmp_eq_u32 s79, 7
    s_cselect_b32 s79, 0, s79
    s_lshl_b32 s46, s79, 14
    s_add_u32 s46, s46, s70
    s_add_u32 s79, s79, 1
    s_cmp_eq_u32 s79, 7
    s_cselect_b32 s79, 0, s79
    s_lshl_b32 s47, s79, 14
    s_add_u32 s47, s47, s70
    s_add_u32 s79, s79, 1
    s_cmp_eq_u32 s79, 7
    s_cselect_b32 s79, 0, s79
    s_lshl_b32 s48, s79, 14
    s_add_u32 s48, s48, s70
    s_add_u32 s79, s79, 1
    s_cmp_eq_u32 s79, 7
    s_cselect_b32 s79, 0, s79
    s_lshl_b32 s49, s79, 14
    s_add_u32 s49, s49, s70
    s_add_u32 s79, s79, 1
    s_cmp_eq_u32 s79, 7
    s_cselect_b32 s79, 0, s79
    s_lshl_b32 s50, s79, 14
    s_add_u32 s50, s50, s70
    s_add_u32 s79, s79, 1
    s_cmp_eq_u32 s79, 7
    s_cselect_b32 s79, 0, s79

    s_setprio 0
    s_waitcnt vmcnt(8)
    s_barrier
    s_add_u32 m0, s69, 53248
    s_add_u32 s68, s68, 114688
    buffer_load_dwordx4 v8, s[20:23], s68 offen lds
    s_add_u32 s67, s67, 1
    s_cmp_eq_u32 s67, 7
    s_cselect_b32 s67, 0, s67
    buffer_load_dwordx4 v9, s[20:23], s68 offen offset:1024 lds
    s_add_u32 m0, s69, 65536
    s_lshl_b32 s68, s67, 7
    s_add_u32 s68, s68, s64
    buffer_load_dwordx4 v6, s[16:19], s68 offen lds
    buffer_load_dwordx4 v7, s[16:19], s68 offen offset:1024 lds
    s_waitcnt vmcnt(10)
    s_barrier
    s_waitcnt vmcnt(4)
    s_barrier
    s_add_u32 m0, s69, 69632
    s_add_u32 s68, s68, 28672
    buffer_load_dwordx4 v6, s[16:19], s68 offen lds
    buffer_load_dwordx4 v7, s[16:19], s68 offen offset:1024 lds
    s_mov_b32 m0, s69
    s_mul_i32 s68, s67, 229376
    s_add_u32 s68, s68, s65
    buffer_load_dwordx4 v8, s[20:23], s68 offen lds
    buffer_load_dwordx4 v9, s[20:23], s68 offen offset:1024 lds
    s_waitcnt vmcnt(6)
    s_barrier
    s_add_u32 m0, s69, 4096
    s_add_u32 s68, s68, 114688
    buffer_load_dwordx4 v8, s[20:23], s68 offen lds
    s_add_u32 s67, s67, 1
    s_cmp_eq_u32 s67, 7
    s_cselect_b32 s67, 0, s67
    buffer_load_dwordx4 v9, s[20:23], s68 offen offset:1024 lds
    s_add_u32 m0, s69, 16384
    s_lshl_b32 s68, s67, 7
    s_add_u32 s68, s68, s64
    buffer_load_dwordx4 v6, s[16:19], s68 offen lds
    buffer_load_dwordx4 v7, s[16:19], s68 offen offset:1024 lds
    s_add_u32 m0, s69, 20480
    s_add_u32 s68, s68, 28672
    buffer_load_dwordx4 v6, s[16:19], s68 offen lds
    buffer_load_dwordx4 v7, s[16:19], s68 offen offset:1024 lds
    s_add_u32 m0, s69, 81920
    s_mul_i32 s68, s67, 229376
    s_add_u32 s68, s68, s65
    buffer_load_dwordx4 v8, s[20:23], s68 offen lds
    buffer_load_dwordx4 v9, s[20:23], s68 offen offset:1024 lds
    s_waitcnt vmcnt(6)
    s_barrier
    s_add_u32 m0, s69, 86016
    s_add_u32 s68, s68, 114688
    buffer_load_dwordx4 v8, s[20:23], s68 offen lds
    s_add_u32 s67, s67, 1
    s_cmp_eq_u32 s67, 7
    s_cselect_b32 s67, 0, s67
    buffer_load_dwordx4 v9, s[20:23], s68 offen offset:1024 lds
    s_add_u32 m0, s69, 32768
    s_lshl_b32 s68, s67, 7
    s_add_u32 s68, s68, s64
    buffer_load_dwordx4 v6, s[16:19], s68 offen lds
    buffer_load_dwordx4 v7, s[16:19], s68 offen offset:1024 lds
    s_add_u32 m0, s69, 36864
    s_add_u32 s68, s68, 28672
    buffer_load_dwordx4 v6, s[16:19], s68 offen lds
    buffer_load_dwordx4 v7, s[16:19], s68 offen offset:1024 lds
    s_add_u32 m0, s69, 98304
    s_mul_i32 s68, s67, 229376
    s_add_u32 s68, s68, s65
    buffer_load_dwordx4 v8, s[20:23], s68 offen lds
    buffer_load_dwordx4 v9, s[20:23], s68 offen offset:1024 lds
    s_add_u32 m0, s69, 102400
    s_add_u32 s68, s68, 114688
    buffer_load_dwordx4 v8, s[20:23], s68 offen lds
    s_add_u32 s67, s67, 1
    s_cmp_eq_u32 s67, 7
    s_cselect_b32 s67, 0, s67
    buffer_load_dwordx4 v9, s[20:23], s68 offen offset:1024 lds
    s_add_u32 m0, s69, 114688
    s_lshl_b32 s68, s67, 7
    s_add_u32 s68, s68, s64
    buffer_load_dwordx4 v6, s[16:19], s68 offen lds
    buffer_load_dwordx4 v7, s[16:19], s68 offen offset:1024 lds
    s_add_u32 m0, s69, 118784
    s_add_u32 s68, s68, 28672
    buffer_load_dwordx4 v6, s[16:19], s68 offen lds
    buffer_load_dwordx4 v7, s[16:19], s68 offen offset:1024 lds
    s_add_u32 m0, s69, 131072
    s_mul_i32 s68, s67, 229376
    s_add_u32 s68, s68, s65
    buffer_load_dwordx4 v8, s[20:23], s68 offen lds
    buffer_load_dwordx4 v9, s[20:23], s68 offen offset:1024 lds
    s_waitcnt vmcnt(14)
    s_barrier
    s_add_u32 m0, s69, 135168
    s_add_u32 s68, s68, 114688
    buffer_load_dwordx4 v8, s[20:23], s68 offen lds
    s_add_u32 s67, s67, 1
    s_cmp_eq_u32 s67, 7
    s_cselect_b32 s67, 0, s67
    buffer_load_dwordx4 v9, s[20:23], s68 offen offset:1024 lds
    s_add_u32 m0, s69, 49152
    s_lshl_b32 s68, s67, 7
    s_add_u32 s68, s68, s64
    buffer_load_dwordx4 v6, s[16:19], s68 offen lds
    buffer_load_dwordx4 v7, s[16:19], s68 offen offset:1024 lds
    s_add_u32 m0, s69, 53248
    s_add_u32 s68, s68, 28672
    buffer_load_dwordx4 v6, s[16:19], s68 offen lds
    buffer_load_dwordx4 v7, s[16:19], s68 offen offset:1024 lds
    s_add_u32 m0, s69, 65536
    s_mul_i32 s68, s67, 229376
    s_add_u32 s68, s68, s65
    buffer_load_dwordx4 v8, s[20:23], s68 offen lds
    buffer_load_dwordx4 v9, s[20:23], s68 offen offset:1024 lds
    s_load_dword s0, s[72:73], 0 glc
    s_load_dword s1, s[72:73], 128 glc
    s_waitcnt vmcnt(14)
    s_barrier
    s_add_u32 m0, s69, 69632
    s_add_u32 s68, s68, 114688
    buffer_load_dwordx4 v8, s[20:23], s68 offen lds
    s_add_u32 s67, s67, 1
    s_cmp_eq_u32 s67, 7
    s_cselect_b32 s67, 0, s67
    buffer_load_dwordx4 v9, s[20:23], s68 offen offset:1024 lds
    s_mov_b32 m0, s69
    s_mul_i32 s68, s24, 229376
    s_add_u32 s68, s68, s65
    s_add_u32 s68, s68, 128
    buffer_load_dwordx4 v8, s[20:23], s68 offen lds
    buffer_load_dwordx4 v9, s[20:23], s68 offen offset:1024 lds
    s_add_u32 m0, s69, 4096
    s_mul_i32 s68, s24, 229376
    s_add_u32 s68, s68, s65
    s_add_u32 s68, s68, 114816
    buffer_load_dwordx4 v8, s[20:23], s68 offen lds
    s_add_u32 s24, s24, 1
    s_cmp_eq_u32 s24, 7
    s_cselect_b32 s24, 0, s24
    buffer_load_dwordx4 v9, s[20:23], s68 offen offset:1024 lds
    s_add_u32 m0, s69, 16384
    s_mul_i32 s68, s24, 229376
    s_add_u32 s68, s68, s65
    s_add_u32 s68, s68, 128
    buffer_load_dwordx4 v8, s[20:23], s68 offen lds
    buffer_load_dwordx4 v9, s[20:23], s68 offen offset:1024 lds
    s_add_u32 m0, s69, 20480
    s_mul_i32 s68, s24, 229376
    s_add_u32 s68, s68, s65
    s_add_u32 s68, s68, 114816
    buffer_load_dwordx4 v8, s[20:23], s68 offen lds
    s_add_u32 s24, s24, 1
    s_cmp_eq_u32 s24, 7
    s_cselect_b32 s24, 0, s24
    buffer_load_dwordx4 v9, s[20:23], s68 offen offset:1024 lds
    s_waitcnt vmcnt(16)
    s_barrier
    s_add_u32 m0, s69, 32768
    s_mul_i32 s68, s24, 229376
    s_add_u32 s68, s68, s65
    s_add_u32 s68, s68, 128
    buffer_load_dwordx4 v8, s[20:23], s68 offen lds
    buffer_load_dwordx4 v9, s[20:23], s68 offen offset:1024 lds
    s_add_u32 m0, s69, 36864
    s_mul_i32 s68, s24, 229376
    s_add_u32 s68, s68, s65
    s_add_u32 s68, s68, 114816
    buffer_load_dwordx4 v8, s[20:23], s68 offen lds
    s_add_u32 s24, s24, 1
    s_cmp_eq_u32 s24, 7
    s_cselect_b32 s24, 0, s24
    buffer_load_dwordx4 v9, s[20:23], s68 offen offset:1024 lds
    s_add_u32 m0, s69, 81920
    s_mul_i32 s68, s24, 229376
    s_add_u32 s68, s68, s65
    s_add_u32 s68, s68, 128
    buffer_load_dwordx4 v8, s[20:23], s68 offen lds
    buffer_load_dwordx4 v9, s[20:23], s68 offen offset:1024 lds
    s_add_u32 m0, s69, 86016
    s_mul_i32 s68, s24, 229376
    s_add_u32 s68, s68, s65
    s_add_u32 s68, s68, 114816
    buffer_load_dwordx4 v8, s[20:23], s68 offen lds
    s_add_u32 s24, s24, 1
    s_cmp_eq_u32 s24, 7
    s_cselect_b32 s24, 0, s24
    buffer_load_dwordx4 v9, s[20:23], s68 offen offset:1024 lds
    s_load_dwordx2 s[74:75], s[36:37], 0
    s_waitcnt vmcnt(16)
    s_barrier
    s_add_u32 m0, s69, 98304
    s_mul_i32 s68, s44, 14
    s_add_u32 s68, s68, s66
    buffer_load_dwordx4 v10, s[28:31], s68 offen lds
    buffer_load_dwordx4 v11, s[28:31], s68 offen offset:1024 lds
    s_add_u32 m0, s69, 102400
    s_mul_i32 s68, s45, 14
    s_add_u32 s68, s68, s66
    buffer_load_dwordx4 v10, s[28:31], s68 offen lds
    buffer_load_dwordx4 v11, s[28:31], s68 offen offset:1024 lds
    s_add_u32 m0, s69, 114688
    s_mul_i32 s68, s46, 14
    s_add_u32 s68, s68, s66
    buffer_load_dwordx4 v10, s[28:31], s68 offen lds
    buffer_load_dwordx4 v11, s[28:31], s68 offen offset:1024 lds
    s_add_u32 m0, s69, 118784
    s_mul_i32 s68, s47, 14
    s_add_u32 s68, s68, s66
    buffer_load_dwordx4 v10, s[28:31], s68 offen lds
    buffer_load_dwordx4 v11, s[28:31], s68 offen offset:1024 lds
    s_waitcnt vmcnt(16)
    s_barrier
    s_add_u32 m0, s69, 49152
    s_mul_i32 s68, s24, 229376
    s_add_u32 s68, s68, s65
    s_add_u32 s68, s68, 128
    buffer_load_dwordx4 v8, s[20:23], s68 offen lds
    buffer_load_dwordx4 v9, s[20:23], s68 offen offset:1024 lds
    s_add_u32 m0, s69, 53248
    s_mul_i32 s68, s24, 229376
    s_add_u32 s68, s68, s65
    s_add_u32 s68, s68, 114816
    buffer_load_dwordx4 v8, s[20:23], s68 offen lds
    s_add_u32 s24, s24, 1
    s_cmp_eq_u32 s24, 7
    s_cselect_b32 s24, 0, s24
    buffer_load_dwordx4 v9, s[20:23], s68 offen offset:1024 lds
    s_add_u32 m0, s69, 131072
    s_mul_i32 s68, s24, 229376
    s_add_u32 s68, s68, s65
    s_add_u32 s68, s68, 128
    buffer_load_dwordx4 v8, s[20:23], s68 offen lds
    buffer_load_dwordx4 v9, s[20:23], s68 offen offset:1024 lds
    s_add_u32 m0, s69, 135168
    s_mul_i32 s68, s24, 229376
    s_add_u32 s68, s68, s65
    s_add_u32 s68, s68, 114816
    buffer_load_dwordx4 v8, s[20:23], s68 offen lds
    s_add_u32 s24, s24, 1
    s_cmp_eq_u32 s24, 7
    s_cselect_b32 s24, 0, s24
    buffer_load_dwordx4 v9, s[20:23], s68 offen offset:1024 lds
    s_waitcnt vmcnt(8)
    s_barrier
    s_add_u32 m0, s69, 65536
    s_mul_i32 s68, s48, 14
    s_add_u32 s68, s68, s66
    buffer_load_dwordx4 v10, s[28:31], s68 offen lds
    buffer_load_dwordx4 v11, s[28:31], s68 offen offset:1024 lds
    s_setprio 3
    ds_read_b64_tr_b16 v[80:81], v14 offset:32768
    ds_read_b64_tr_b16 v[82:83], v14 offset:34816
    ds_read_b64_tr_b16 v[84:85], v17 offset:32768
    ds_read_b64_tr_b16 v[86:87], v17 offset:34816
    ds_read_b64_tr_b16 v[88:89], v14 offset:36864
    ds_read_b64_tr_b16 v[90:91], v14 offset:38912
    ds_read_b64_tr_b16 v[92:93], v17 offset:36864
    ds_read_b64_tr_b16 v[94:95], v17 offset:38912
    ds_read_b64_tr_b16 v[96:97], v14 offset:49152
    ds_read_b64_tr_b16 v[98:99], v14 offset:51200
    ds_read_b64_tr_b16 v[100:101], v17 offset:49152
    ds_read_b64_tr_b16 v[102:103], v17 offset:51200
    ds_read_b64_tr_b16 v[104:105], v14 offset:53248
    ds_read_b64_tr_b16 v[106:107], v14 offset:55296
    ds_read_b64_tr_b16 v[108:109], v17 offset:53248
    s_waitcnt lgkmcnt(14)
    ds_read_b64_tr_b16 v[110:111], v17 offset:55296
    s_setprio 0
    s_add_u32 m0, s69, 69632
    s_mul_i32 s68, s49, 14
    s_add_u32 s68, s68, s66
    buffer_load_dwordx4 v10, s[28:31], s68 offen lds
    buffer_load_dwordx4 v11, s[28:31], s68 offen offset:1024 lds
    s_waitcnt lgkmcnt(0)
    s_cmp_lg_u32 s75, 0
    s_cbranch_scc0 L_slS0
L_ckS0:
    s_barrier
    s_add_u32 m0, s69, 98304
    s_mul_i32 s68, s24, 229376
    s_add_u32 s68, s68, s65
    s_add_u32 s68, s68, 128
    buffer_load_dwordx4 v8, s[20:23], s68 offen lds
    buffer_load_dwordx4 v9, s[20:23], s68 offen offset:1024 lds
    s_add_u32 m0, s69, 102400
    s_mul_i32 s68, s24, 229376
    s_add_u32 s68, s68, s65
    s_add_u32 s68, s68, 114816
    buffer_load_dwordx4 v8, s[20:23], s68 offen lds
    s_add_u32 s24, s24, 1
    s_cmp_eq_u32 s24, 7
    s_cselect_b32 s24, 0, s24
    buffer_load_dwordx4 v9, s[20:23], s68 offen offset:1024 lds
    s_add_u32 m0, s69, 114688
    s_mul_i32 s68, s50, 14
    s_add_u32 s68, s68, s66
    buffer_load_dwordx4 v10, s[28:31], s68 offen lds
    buffer_load_dwordx4 v11, s[28:31], s68 offen offset:1024 lds
    s_waitcnt vmcnt(6)
    s_barrier
    s_mov_b32 m0, s69
    s_mul_i32 s68, s44, 14
    s_add_u32 s68, s68, s66
    s_add_u32 s68, s68, 28672
    buffer_load_dwordx4 v10, s[28:31], s68 offen lds
    buffer_load_dwordx4 v11, s[28:31], s68 offen offset:1024 lds
    s_setprio 3
    ds_read_b64_tr_b16 v[112:113], v14 offset:0
    ds_read_b64_tr_b16 v[114:115], v14 offset:2048
    ds_read_b64_tr_b16 v[116:117], v17 offset:0
    ds_read_b64_tr_b16 v[118:119], v17 offset:2048
    ds_read_b64_tr_b16 v[120:121], v14 offset:4096
    ds_read_b64_tr_b16 v[122:123], v14 offset:6144
    ds_read_b64_tr_b16 v[124:125], v17 offset:4096
    ds_read_b64_tr_b16 v[126:127], v17 offset:6144
    s_setprio 0
    s_add_u32 m0, s69, 118784
    s_mul_i32 s68, s45, 14
    s_add_u32 s68, s68, s66
    s_add_u32 s68, s68, 28672
    buffer_load_dwordx4 v10, s[28:31], s68 offen lds
    buffer_load_dwordx4 v11, s[28:31], s68 offen offset:1024 lds
    s_add_u32 m0, s69, 147456
    s_mul_i32 s68, s46, 14
    s_add_u32 s68, s68, s66
    s_add_u32 s68, s68, 28672
    buffer_load_dwordx4 v10, s[28:31], s68 offen lds
    buffer_load_dwordx4 v11, s[28:31], s68 offen offset:1024 lds
    s_add_u32 m0, s69, 151552
    s_mul_i32 s68, s47, 14
    s_add_u32 s68, s68, s66
    s_add_u32 s68, s68, 28672
    buffer_load_dwordx4 v10, s[28:31], s68 offen lds
    buffer_load_dwordx4 v11, s[28:31], s68 offen offset:1024 lds
    s_waitcnt lgkmcnt(0)
    s_waitcnt vmcnt(8)
    s_barrier
    s_add_u32 m0, s69, 4096
    s_mul_i32 s68, s48, 14
    s_add_u32 s68, s68, s66
    s_add_u32 s68, s68, 28672
    buffer_load_dwordx4 v10, s[28:31], s68 offen lds
    buffer_load_dwordx4 v11, s[28:31], s68 offen offset:1024 lds
    s_setprio 3
    ds_read_b64_tr_b16 v[128:129], v14 offset:49152
    ds_read_b64_tr_b16 v[130:131], v14 offset:51200
    ds_read_b64_tr_b16 v[132:133], v17 offset:49152
    ds_read_b64_tr_b16 v[134:135], v17 offset:51200
    s_setprio 0
    s_add_u32 m0, s69, 16384
    s_mul_i32 s68, s49, 14
    s_add_u32 s68, s68, s66
    s_add_u32 s68, s68, 28672
    buffer_load_dwordx4 v10, s[28:31], s68 offen lds
    buffer_load_dwordx4 v11, s[28:31], s68 offen offset:1024 lds
    s_add_u32 m0, s69, 65536
    s_mul_i32 s68, s50, 14
    s_add_u32 s68, s68, s66
    s_add_u32 s68, s68, 28672
    buffer_load_dwordx4 v10, s[28:31], s68 offen lds
    buffer_load_dwordx4 v11, s[28:31], s68 offen offset:1024 lds
    s_add_u32 m0, s69, 69632
    s_mul_i32 s68, s44, 14
    s_add_u32 s68, s68, s66
    s_add_u32 s68, s68, 57344
    buffer_load_dwordx4 v10, s[28:31], s68 offen lds
    buffer_load_dwordx4 v11, s[28:31], s68 offen offset:1024 lds
    s_waitcnt lgkmcnt(0)
    s_waitcnt vmcnt(8)
    s_barrier
    s_add_u32 m0, s69, 20480
    s_mul_i32 s68, s45, 14
    s_add_u32 s68, s68, s66
    s_add_u32 s68, s68, 57344
    buffer_load_dwordx4 v10, s[28:31], s68 offen lds
    buffer_load_dwordx4 v11, s[28:31], s68 offen offset:1024 lds
    s_setprio 3
    ds_read_b64_tr_b16 v[136:137], v13 offset:0
    ds_read_b64_tr_b16 v[138:139], v13 offset:2048
    ds_read_b64_tr_b16 v[140:141], v16 offset:0
    ds_read_b64_tr_b16 v[142:143], v16 offset:2048
    ds_read_b64_tr_b16 v[144:145], v14 offset:53248
    ds_read_b64_tr_b16 v[146:147], v14 offset:55296
    ds_read_b64_tr_b16 v[148:149], v17 offset:53248
    ds_read_b64_tr_b16 v[150:151], v17 offset:55296
    ds_read_b64_tr_b16 v[152:153], v15 offset:16384
    ds_read_b64_tr_b16 v[154:155], v15 offset:18432
    ds_read_b64_tr_b16 v[156:157], v18 offset:16384
    ds_read_b64_tr_b16 v[158:159], v18 offset:18432
    ds_read_b64_tr_b16 v[160:161], v15 offset:20480
    ds_read_b64_tr_b16 v[162:163], v15 offset:22528
    ds_read_b64_tr_b16 v[164:165], v18 offset:20480
    s_waitcnt lgkmcnt(14)
    ds_read_b64_tr_b16 v[166:167], v18 offset:22528
    s_setprio 0
    s_add_u32 m0, s69, 32768
    s_mul_i32 s68, s46, 14
    s_add_u32 s68, s68, s66
    s_add_u32 s68, s68, 57344
    buffer_load_dwordx4 v10, s[28:31], s68 offen lds
    buffer_load_dwordx4 v11, s[28:31], s68 offen offset:1024 lds
    s_add_u32 m0, s69, 114688
    s_mul_i32 s68, s47, 14
    s_add_u32 s68, s68, s66
    s_add_u32 s68, s68, 57344
    buffer_load_dwordx4 v10, s[28:31], s68 offen lds
    buffer_load_dwordx4 v11, s[28:31], s68 offen offset:1024 lds
    s_waitcnt lgkmcnt(0)
    s_waitcnt vmcnt(6)
    s_barrier
    s_mov_b32 m0, s69
    s_mul_i32 s68, s48, 14
    s_add_u32 s68, s68, s66
    s_add_u32 s68, s68, 57344
    buffer_load_dwordx4 v10, s[28:31], s68 offen lds
    buffer_load_dwordx4 v11, s[28:31], s68 offen offset:1024 lds
    s_setprio 3
    ds_read_b64_tr_b16 v[168:169], v13 offset:4096
    ds_read_b64_tr_b16 v[170:171], v13 offset:6144
    ds_read_b64_tr_b16 v[172:173], v16 offset:4096
    ds_read_b64_tr_b16 v[174:175], v16 offset:6144
    ds_read_b64_tr_b16 v[176:177], v13 offset:16384
    ds_read_b64_tr_b16 v[178:179], v13 offset:18432
    ds_read_b64_tr_b16 v[180:181], v16 offset:16384
    ds_read_b64_tr_b16 v[182:183], v16 offset:18432
    ds_read_b64_tr_b16 v[184:185], v14 offset:0
    ds_read_b64_tr_b16 v[186:187], v14 offset:2048
    ds_read_b64_tr_b16 v[188:189], v17 offset:0
    ds_read_b64_tr_b16 v[190:191], v17 offset:2048
    ds_read_b64_tr_b16 v[192:193], v14 offset:4096
    ds_read_b64_tr_b16 v[194:195], v14 offset:6144
    ds_read_b64_tr_b16 v[196:197], v17 offset:4096
    s_waitcnt lgkmcnt(14)
    ds_read_b64_tr_b16 v[198:199], v17 offset:6144
    s_setprio 0
    s_add_u32 m0, s69, 36864
    s_mul_i32 s68, s49, 14
    s_add_u32 s68, s68, s66
    s_add_u32 s68, s68, 57344
    buffer_load_dwordx4 v10, s[28:31], s68 offen lds
    buffer_load_dwordx4 v11, s[28:31], s68 offen offset:1024 lds
    s_add_u32 m0, s69, 81920
    s_mul_i32 s68, s50, 14
    s_add_u32 s68, s68, s66
    s_add_u32 s68, s68, 57344
    buffer_load_dwordx4 v10, s[28:31], s68 offen lds
    buffer_load_dwordx4 v11, s[28:31], s68 offen offset:1024 lds
    s_waitcnt lgkmcnt(0)
    s_waitcnt vmcnt(6)
    s_barrier
    s_add_u32 m0, s69, 4096
    s_mul_i32 s68, s44, 14
    s_add_u32 s68, s68, s66
    s_add_u32 s68, s68, 86016
    buffer_load_dwordx4 v10, s[28:31], s68 offen lds
    buffer_load_dwordx4 v11, s[28:31], s68 offen offset:1024 lds
    s_setprio 3
    ds_read_b64_tr_b16 v[200:201], v13 offset:20480
    ds_read_b64_tr_b16 v[202:203], v13 offset:22528
    ds_read_b64_tr_b16 v[204:205], v16 offset:20480
    ds_read_b64_tr_b16 v[206:207], v16 offset:22528
    ds_read_b64_tr_b16 v[208:209], v13 offset:32768
    ds_read_b64_tr_b16 v[210:211], v13 offset:34816
    ds_read_b64_tr_b16 v[212:213], v16 offset:32768
    ds_read_b64_tr_b16 v[214:215], v16 offset:34816
    ds_read_b64_tr_b16 v[216:217], v14 offset:49152
    ds_read_b64_tr_b16 v[218:219], v14 offset:51200
    ds_read_b64_tr_b16 v[220:221], v17 offset:49152
    ds_read_b64_tr_b16 v[222:223], v17 offset:51200
    s_setprio 0
    s_add_u32 m0, s69, 16384
    s_mul_i32 s68, s45, 14
    s_add_u32 s68, s68, s66
    s_add_u32 s68, s68, 86016
    buffer_load_dwordx4 v10, s[28:31], s68 offen lds
    buffer_load_dwordx4 v11, s[28:31], s68 offen offset:1024 lds
    s_add_u32 m0, s69, 86016
    s_mul_i32 s68, s46, 14
    s_add_u32 s68, s68, s66
    s_add_u32 s68, s68, 86016
    buffer_load_dwordx4 v10, s[28:31], s68 offen lds
    buffer_load_dwordx4 v11, s[28:31], s68 offen offset:1024 lds
    s_waitcnt lgkmcnt(0)
    s_load_dwordx16 s[0:15], s[72:73], 0 glc
    s_barrier
    s_waitcnt lgkmcnt(0)
    s_xor_b64 s[0:1], s[0:1], s[74:75]
    s_xor_b64 s[2:3], s[2:3], s[74:75]
    s_xor_b64 s[4:5], s[4:5], s[74:75]
    s_xor_b64 s[6:7], s[6:7], s[74:75]
    s_xor_b64 s[8:9], s[8:9], s[74:75]
    s_xor_b64 s[10:11], s[10:11], s[74:75]
    s_xor_b64 s[12:13], s[12:13], s[74:75]
    s_or_b64 s[0:1], s[0:1], s[2:3]
    s_or_b64 s[0:1], s[0:1], s[4:5]
    s_or_b64 s[0:1], s[0:1], s[6:7]
    s_or_b64 s[0:1], s[0:1], s[8:9]
    s_or_b64 s[0:1], s[0:1], s[10:11]
    s_or_b64 s[0:1], s[0:1], s[12:13]
    s_cbranch_scc1 L_gs0
    s_add_u32 m0, s27, 20480
    s_add_u32 s68, s44, 0
    buffer_load_dwordx4 v12, s[32:35], s68 offen sc1 lds
    buffer_load_dwordx4 v12, s[32:35], s68 offen offset:1024 sc1 lds
    s_add_u32 m0, s27, 32768
    s_add_u32 s68, s45, 0
    buffer_load_dwordx4 v12, s[32:35], s68 offen sc1 lds
    buffer_load_dwordx4 v12, s[32:35], s68 offen offset:1024 sc1 lds
    s_add_u32 m0, s27, 49152
    s_add_u32 s68, s46, 0
    buffer_load_dwordx4 v12, s[32:35], s68 offen sc1 lds
    buffer_load_dwordx4 v12, s[32:35], s68 offen offset:1024 sc1 lds
    s_add_u32 m0, s27, 53248
    s_add_u32 s68, s47, 0
    buffer_load_dwordx4 v12, s[32:35], s68 offen sc1 lds
    buffer_load_dwordx4 v12, s[32:35], s68 offen offset:1024 sc1 lds
    s_barrier
L_gf0:
    s_load_dwordx16 s[0:15], s[72:73], 64 glc
    s_add_u32 m0, s27, 65536
    s_add_u32 s68, s48, 0
    buffer_load_dwordx4 v12, s[32:35], s68 offen sc1 lds
    buffer_load_dwordx4 v12, s[32:35], s68 offen offset:1024 sc1 lds
    s_add_u32 m0, s27, 69632
    s_add_u32 s68, s49, 0
    buffer_load_dwordx4 v12, s[32:35], s68 offen sc1 lds
    buffer_load_dwordx4 v12, s[32:35], s68 offen offset:1024 sc1 lds
    s_add_u32 m0, s27, 98304
    s_add_u32 s68, s50, 0
    buffer_load_dwordx4 v12, s[32:35], s68 offen sc1 lds
    buffer_load_dwordx4 v12, s[32:35], s68 offen offset:1024 sc1 lds
    s_waitcnt lgkmcnt(0)
    s_xor_b64 s[0:1], s[0:1], s[74:75]
    s_xor_b64 s[2:3], s[2:3], s[74:75]
    s_xor_b64 s[4:5], s[4:5], s[74:75]
    s_xor_b64 s[6:7], s[6:7], s[74:75]
    s_xor_b64 s[8:9], s[8:9], s[74:75]
    s_xor_b64 s[10:11], s[10:11], s[74:75]
    s_xor_b64 s[12:13], s[12:13], s[74:75]
    s_or_b64 s[0:1], s[0:1], s[2:3]
    s_or_b64 s[0:1], s[0:1], s[4:5]
    s_or_b64 s[0:1], s[0:1], s[6:7]
    s_or_b64 s[0:1], s[0:1], s[8:9]
    s_or_b64 s[0:1], s[0:1], s[10:11]
    s_or_b64 s[0:1], s[0:1], s[12:13]
    s_cbranch_scc1 L_gs1
    s_add_u32 m0, s27, 102400
    s_add_u32 s68, s44, 2048
    buffer_load_dwordx4 v12, s[32:35], s68 offen sc1 lds
    buffer_load_dwordx4 v12, s[32:35], s68 offen offset:1024 sc1 lds
    s_add_u32 m0, s27, 114688
    s_add_u32 s68, s45, 2048
    buffer_load_dwordx4 v12, s[32:35], s68 offen sc1 lds
    buffer_load_dwordx4 v12, s[32:35], s68 offen offset:1024 sc1 lds
    s_add_u32 m0, s27, 118784
    s_add_u32 s68, s46, 2048
    buffer_load_dwordx4 v12, s[32:35], s68 offen sc1 lds
    buffer_load_dwordx4 v12, s[32:35], s68 offen offset:1024 sc1 lds
    s_add_u32 m0, s27, 131072
    s_add_u32 s68, s47, 2048
    buffer_load_dwordx4 v12, s[32:35], s68 offen sc1 lds
    buffer_load_dwordx4 v12, s[32:35], s68 offen offset:1024 sc1 lds
    s_add_u32 m0, s27, 135168
    s_add_u32 s68, s48, 2048
    buffer_load_dwordx4 v12, s[32:35], s68 offen sc1 lds
    buffer_load_dwordx4 v12, s[32:35], s68 offen offset:1024 sc1 lds
    s_waitcnt vmcnt(12)
    s_barrier
L_gf1:
    ds_read_b128 v[56:59], v19 offset:20480
    s_setprio 3
    ds_read_b128 v[60:63], v19 offset:21504
    ds_read_b128 v[64:67], v19 offset:22528
    ds_read_b128 v[68:71], v19 offset:23552
    ds_read_b128 v[72:75], v19 offset:32768
    s_waitcnt lgkmcnt(4)
    v_mfma_f32_16x16x32_bf16 v[24:27], v[80:83], v[56:59], 0
    ds_read_b128 v[76:79], v19 offset:33792
    v_mfma_f32_16x16x32_bf16 v[28:31], v[84:87], v[56:59], 0
    s_waitcnt lgkmcnt(4)
    v_mfma_f32_16x16x32_bf16 v[32:35], v[80:83], v[60:63], 0
    ds_read_b128 v[56:59], v19 offset:34816
    v_mfma_f32_16x16x32_bf16 v[36:39], v[84:87], v[60:63], 0
    s_waitcnt lgkmcnt(4)
    v_mfma_f32_16x16x32_bf16 v[40:43], v[80:83], v[64:67], 0
    ds_read_b128 v[60:63], v19 offset:35840
    v_mfma_f32_16x16x32_bf16 v[44:47], v[84:87], v[64:67], 0
    s_waitcnt lgkmcnt(4)
    v_mfma_f32_16x16x32_bf16 v[48:51], v[80:83], v[68:71], 0
    ds_read_b128 v[64:67], v19 offset:49152
    v_mfma_f32_16x16x32_bf16 v[52:55], v[84:87], v[68:71], 0
    s_waitcnt lgkmcnt(4)
    v_mfma_f32_16x16x32_bf16 v[24:27], v[88:91], v[72:75], v[24:27]
    ds_read_b128 v[68:71], v19 offset:50176
    v_mfma_f32_16x16x32_bf16 v[28:31], v[92:95], v[72:75], v[28:31]
    s_waitcnt lgkmcnt(4)
    v_mfma_f32_16x16x32_bf16 v[32:35], v[88:91], v[76:79], v[32:35]
    ds_read_b128 v[72:75], v19 offset:51200
    v_mfma_f32_16x16x32_bf16 v[36:39], v[92:95], v[76:79], v[36:39]
    s_waitcnt lgkmcnt(4)
    v_mfma_f32_16x16x32_bf16 v[40:43], v[88:91], v[56:59], v[40:43]
    ds_read_b128 v[76:79], v19 offset:52224
    v_mfma_f32_16x16x32_bf16 v[44:47], v[92:95], v[56:59], v[44:47]
    s_waitcnt lgkmcnt(4)
    v_mfma_f32_16x16x32_bf16 v[48:51], v[88:91], v[60:63], v[48:51]
    ds_read_b128 v[56:59], v19 offset:53248
    v_mfma_f32_16x16x32_bf16 v[52:55], v[92:95], v[60:63], v[52:55]
    s_waitcnt lgkmcnt(4)
    v_mfma_f32_16x16x32_bf16 v[24:27], v[96:99], v[64:67], v[24:27]
    ds_read_b128 v[60:63], v19 offset:54272
    v_mfma_f32_16x16x32_bf16 v[28:31], v[100:103], v[64:67], v[28:31]
    s_waitcnt lgkmcnt(4)
    v_mfma_f32_16x16x32_bf16 v[32:35], v[96:99], v[68:71], v[32:35]
    ds_read_b128 v[64:67], v19 offset:55296
    v_mfma_f32_16x16x32_bf16 v[36:39], v[100:103], v[68:71], v[36:39]
    s_waitcnt lgkmcnt(4)
    v_mfma_f32_16x16x32_bf16 v[40:43], v[96:99], v[72:75], v[40:43]
    ds_read_b128 v[68:71], v19 offset:56320
    v_mfma_f32_16x16x32_bf16 v[44:47], v[100:103], v[72:75], v[44:47]
    s_waitcnt lgkmcnt(4)
    v_mfma_f32_16x16x32_bf16 v[48:51], v[96:99], v[76:79], v[48:51]
    ds_read_b128 v[72:75], v20 offset:0
    v_mfma_f32_16x16x32_bf16 v[52:55], v[100:103], v[76:79], v[52:55]
    s_waitcnt lgkmcnt(4)
    v_mfma_f32_16x16x32_bf16 v[24:27], v[104:107], v[56:59], v[24:27]
    ds_read_b128 v[76:79], v20 offset:1024
    v_mfma_f32_16x16x32_bf16 v[28:31], v[108:111], v[56:59], v[28:31]
    s_waitcnt lgkmcnt(4)
    v_mfma_f32_16x16x32_bf16 v[32:35], v[104:107], v[60:63], v[32:35]
    ds_read_b128 v[56:59], v20 offset:2048
    v_mfma_f32_16x16x32_bf16 v[36:39], v[108:111], v[60:63], v[36:39]
    s_waitcnt lgkmcnt(4)
    v_mfma_f32_16x16x32_bf16 v[40:43], v[104:107], v[64:67], v[40:43]
    ds_read_b128 v[60:63], v20 offset:3072
    v_mfma_f32_16x16x32_bf16 v[44:47], v[108:111], v[64:67], v[44:47]
    s_waitcnt lgkmcnt(4)
    v_mfma_f32_16x16x32_bf16 v[48:51], v[104:107], v[68:71], v[48:51]
    ds_read_b128 v[64:67], v20 offset:4096
    v_mfma_f32_16x16x32_bf16 v[52:55], v[108:111], v[68:71], v[52:55]
    s_waitcnt lgkmcnt(4)
    v_mfma_f32_16x16x32_bf16 v[24:27], v[112:115], v[72:75], v[24:27]
    ds_read_b128 v[68:71], v20 offset:5120
    v_mfma_f32_16x16x32_bf16 v[28:31], v[116:119], v[72:75], v[28:31]
    s_waitcnt lgkmcnt(4)
    v_mfma_f32_16x16x32_bf16 v[32:35], v[112:115], v[76:79], v[32:35]
    ds_read_b128 v[72:75], v20 offset:6144
    v_mfma_f32_16x16x32_bf16 v[36:39], v[116:119], v[76:79], v[36:39]
    s_waitcnt lgkmcnt(4)
    v_mfma_f32_16x16x32_bf16 v[40:43], v[112:115], v[56:59], v[40:43]
    ds_read_b128 v[76:79], v20 offset:7168
    v_mfma_f32_16x16x32_bf16 v[44:47], v[116:119], v[56:59], v[44:47]
    s_waitcnt lgkmcnt(4)
    v_mfma_f32_16x16x32_bf16 v[48:51], v[112:115], v[60:63], v[48:51]
    s_waitcnt vmcnt(6)
    s_barrier
    ds_read_b128 v[56:59], v20 offset:32768
    v_mfma_f32_16x16x32_bf16 v[52:55], v[116:119], v[60:63], v[52:55]
    s_waitcnt lgkmcnt(4)
    v_mfma_f32_16x16x32_bf16 v[24:27], v[120:123], v[64:67], v[24:27]
    ds_read_b128 v[60:63], v20 offset:33792
    v_mfma_f32_16x16x32_bf16 v[28:31], v[124:127], v[64:67], v[28:31]
    s_waitcnt lgkmcnt(4)
    v_mfma_f32_16x16x32_bf16 v[32:35], v[120:123], v[68:71], v[32:35]
    ds_read_b128 v[64:67], v20 offset:34816
    v_mfma_f32_16x16x32_bf16 v[36:39], v[124:127], v[68:71], v[36:39]
    s_waitcnt lgkmcnt(4)
    v_mfma_f32_16x16x32_bf16 v[40:43], v[120:123], v[72:75], v[40:43]
    ds_read_b128 v[68:71], v20 offset:35840
    v_mfma_f32_16x16x32_bf16 v[44:47], v[124:127], v[72:75], v[44:47]
    s_waitcnt lgkmcnt(4)
    v_mfma_f32_16x16x32_bf16 v[48:51], v[120:123], v[76:79], v[48:51]
    ds_read_b128 v[72:75], v20 offset:36864
    v_mfma_f32_16x16x32_bf16 v[52:55], v[124:127], v[76:79], v[52:55]
    s_waitcnt lgkmcnt(4)
    v_mfma_f32_16x16x32_bf16 v[24:27], v[128:131], v[56:59], v[24:27]
    ds_read_b128 v[76:79], v20 offset:37888
    v_mfma_f32_16x16x32_bf16 v[28:31], v[132:135], v[56:59], v[28:31]
    s_waitcnt lgkmcnt(4)
    v_mfma_f32_16x16x32_bf16 v[32:35], v[128:131], v[60:63], v[32:35]
    ds_read_b128 v[56:59], v20 offset:38912
    v_mfma_f32_16x16x32_bf16 v[36:39], v[132:135], v[60:63], v[36:39]
    s_waitcnt lgkmcnt(4)
    v_mfma_f32_16x16x32_bf16 v[40:43], v[128:131], v[64:67], v[40:43]
    ds_read_b128 v[60:63], v20 offset:39936
    v_mfma_f32_16x16x32_bf16 v[44:47], v[132:135], v[64:67], v[44:47]
    s_waitcnt lgkmcnt(4)
    v_mfma_f32_16x16x32_bf16 v[48:51], v[128:131], v[68:71], v[48:51]
    ds_read_b128 v[64:67], v20 offset:49152
    v_mfma_f32_16x16x32_bf16 v[52:55], v[132:135], v[68:71], v[52:55]
    s_waitcnt lgkmcnt(4)
    v_mfma_f32_16x16x32_bf16 v[24:27], v[136:139], v[72:75], v[24:27]
    ds_read_b128 v[68:71], v20 offset:50176
    v_mfma_f32_16x16x32_bf16 v[28:31], v[140:143], v[72:75], v[28:31]
    s_waitcnt lgkmcnt(4)
    v_mfma_f32_16x16x32_bf16 v[32:35], v[136:139], v[76:79], v[32:35]
    ds_read_b128 v[72:75], v20 offset:51200
    v_mfma_f32_16x16x32_bf16 v[36:39], v[140:143], v[76:79], v[36:39]
    s_waitcnt lgkmcnt(4)
    v_mfma_f32_16x16x32_bf16 v[40:43], v[136:139], v[56:59], v[40:43]
    ds_read_b128 v[76:79], v20 offset:52224
    v_mfma_f32_16x16x32_bf16 v[44:47], v[140:143], v[56:59], v[44:47]
    s_waitcnt lgkmcnt(4)
    v_mfma_f32_16x16x32_bf16 v[48:51], v[136:139], v[60:63], v[48:51]
    s_waitcnt vmcnt(0)
    s_barrier
    ds_read_b128 v[56:59], v20 offset:53248
    v_mfma_f32_16x16x32_bf16 v[52:55], v[140:143], v[60:63], v[52:55]
    s_waitcnt lgkmcnt(4)
    v_mfma_f32_16x16x32_bf16 v[24:27], v[144:147], v[64:67], v[24:27]
    ds_read_b128 v[60:63], v20 offset:54272
    v_mfma_f32_16x16x32_bf16 v[28:31], v[148:151], v[64:67], v[28:31]
    s_waitcnt lgkmcnt(4)
    v_mfma_f32_16x16x32_bf16 v[32:35], v[144:147], v[68:71], v[32:35]
    ds_read_b128 v[64:67], v20 offset:55296
    v_mfma_f32_16x16x32_bf16 v[36:39], v[148:151], v[68:71], v[36:39]
    s_waitcnt lgkmcnt(4)
    v_mfma_f32_16x16x32_bf16 v[40:43], v[144:147], v[72:75], v[40:43]
    ds_read_b128 v[68:71], v20 offset:56320
    v_mfma_f32_16x16x32_bf16 v[44:47], v[148:151], v[72:75], v[44:47]
    s_waitcnt lgkmcnt(4)
    v_mfma_f32_16x16x32_bf16 v[48:51], v[144:147], v[76:79], v[48:51]
    ds_read_b128 v[72:75], v21 offset:0
    v_mfma_f32_16x16x32_bf16 v[52:55], v[148:151], v[76:79], v[52:55]
    s_waitcnt lgkmcnt(4)
    v_mfma_f32_16x16x32_bf16 v[24:27], v[152:155], v[56:59], v[24:27]
    ds_read_b128 v[76:79], v21 offset:1024
    v_mfma_f32_16x16x32_bf16 v[28:31], v[156:159], v[56:59], v[28:31]
    s_waitcnt lgkmcnt(4)
    v_mfma_f32_16x16x32_bf16 v[32:35], v[152:155], v[60:63], v[32:35]
    ds_read_b128 v[56:59], v21 offset:2048
    v_mfma_f32_16x16x32_bf16 v[36:39], v[156:159], v[60:63], v[36:39]
    s_waitcnt lgkmcnt(4)
    v_mfma_f32_16x16x32_bf16 v[40:43], v[152:155], v[64:67], v[40:43]
    ds_read_b128 v[60:63], v21 offset:3072
    v_mfma_f32_16x16x32_bf16 v[44:47], v[156:159], v[64:67], v[44:47]
    s_waitcnt lgkmcnt(4)
    v_mfma_f32_16x16x32_bf16 v[48:51], v[152:155], v[68:71], v[48:51]
    ds_read_b128 v[64:67], v21 offset:4096
    v_mfma_f32_16x16x32_bf16 v[52:55], v[156:159], v[68:71], v[52:55]
    s_waitcnt lgkmcnt(4)
    v_mfma_f32_16x16x32_bf16 v[24:27], v[160:163], v[72:75], v[24:27]
    ds_read_b128 v[68:71], v21 offset:5120
    v_mfma_f32_16x16x32_bf16 v[28:31], v[164:167], v[72:75], v[28:31]
    s_waitcnt lgkmcnt(4)
    v_mfma_f32_16x16x32_bf16 v[32:35], v[160:163], v[76:79], v[32:35]
    ds_read_b128 v[72:75], v21 offset:6144
    v_mfma_f32_16x16x32_bf16 v[36:39], v[164:167], v[76:79], v[36:39]
    s_waitcnt lgkmcnt(4)
    v_mfma_f32_16x16x32_bf16 v[40:43], v[160:163], v[56:59], v[40:43]
    ds_read_b128 v[76:79], v21 offset:7168
    v_mfma_f32_16x16x32_bf16 v[44:47], v[164:167], v[56:59], v[44:47]
    s_waitcnt lgkmcnt(4)
    v_mfma_f32_16x16x32_bf16 v[48:51], v[160:163], v[60:63], v[48:51]
    s_barrier
    ds_read_b128 v[56:59], v21 offset:16384
    v_mfma_f32_16x16x32_bf16 v[52:55], v[164:167], v[60:63], v[52:55]
    s_waitcnt lgkmcnt(4)
    v_mfma_f32_16x16x32_bf16 v[24:27], v[168:171], v[64:67], v[24:27]
    ds_read_b128 v[60:63], v21 offset:17408
    v_mfma_f32_16x16x32_bf16 v[28:31], v[172:175], v[64:67], v[28:31]
    s_waitcnt lgkmcnt(4)
    v_mfma_f32_16x16x32_bf16 v[32:35], v[168:171], v[68:71], v[32:35]
    ds_read_b128 v[64:67], v21 offset:18432
    v_mfma_f32_16x16x32_bf16 v[36:39], v[172:175], v[68:71], v[36:39]
    s_waitcnt lgkmcnt(4)
    v_mfma_f32_16x16x32_bf16 v[40:43], v[168:171], v[72:75], v[40:43]
    ds_read_b128 v[68:71], v21 offset:19456
    v_mfma_f32_16x16x32_bf16 v[44:47], v[172:175], v[72:75], v[44:47]
    s_waitcnt lgkmcnt(4)
    v_mfma_f32_16x16x32_bf16 v[48:51], v[168:171], v[76:79], v[48:51]
    ds_read_b128 v[72:75], v21 offset:20480
    v_mfma_f32_16x16x32_bf16 v[52:55], v[172:175], v[76:79], v[52:55]
    s_waitcnt lgkmcnt(4)
    v_mfma_f32_16x16x32_bf16 v[24:27], v[176:179], v[56:59], v[24:27]
    ds_read_b128 v[76:79], v21 offset:21504
    v_mfma_f32_16x16x32_bf16 v[28:31], v[180:183], v[56:59], v[28:31]
    s_waitcnt lgkmcnt(4)
    v_mfma_f32_16x16x32_bf16 v[32:35], v[176:179], v[60:63], v[32:35]
    ds_read_b128 v[56:59], v21 offset:22528
    v_mfma_f32_16x16x32_bf16 v[36:39], v[180:183], v[60:63], v[36:39]
    s_waitcnt lgkmcnt(4)
    v_mfma_f32_16x16x32_bf16 v[40:43], v[176:179], v[64:67], v[40:43]
    ds_read_b128 v[60:63], v21 offset:23552
    v_mfma_f32_16x16x32_bf16 v[44:47], v[180:183], v[64:67], v[44:47]
    s_waitcnt lgkmcnt(4)
    v_mfma_f32_16x16x32_bf16 v[48:51], v[176:179], v[68:71], v[48:51]
    ds_read_b128 v[64:67], v19 offset:20480
    v_mfma_f32_16x16x32_bf16 v[52:55], v[180:183], v[68:71], v[52:55]
    s_waitcnt lgkmcnt(4)
    v_mfma_f32_16x16x32_bf16 v[24:27], v[184:187], v[72:75], v[24:27]
    ds_read_b128 v[68:71], v19 offset:21504
    v_mfma_f32_16x16x32_bf16 v[28:31], v[188:191], v[72:75], v[28:31]
    ds_read_b64_tr_b16 v[224:225], v13 offset:0
    s_waitcnt lgkmcnt(5)
    v_mfma_f32_16x16x32_bf16 v[32:35], v[184:187], v[76:79], v[32:35]
    ds_read_b128 v[72:75], v19 offset:22528
    v_mfma_f32_16x16x32_bf16 v[36:39], v[188:191], v[76:79], v[36:39]
    ds_read_b64_tr_b16 v[226:227], v13 offset:2048
    s_waitcnt lgkmcnt(6)
    v_mfma_f32_16x16x32_bf16 v[40:43], v[184:187], v[56:59], v[40:43]
    ds_read_b128 v[76:79], v19 offset:23552
    v_mfma_f32_16x16x32_bf16 v[44:47], v[188:191], v[56:59], v[44:47]
    ds_read_b64_tr_b16 v[228:229], v16 offset:0
    s_waitcnt lgkmcnt(7)
    v_mfma_f32_16x16x32_bf16 v[48:51], v[184:187], v[60:63], v[48:51]
    ds_read_b128 v[56:59], v19 offset:32768
    v_mfma_f32_16x16x32_bf16 v[52:55], v[188:191], v[60:63], v[52:55]
    ds_read_b64_tr_b16 v[230:231], v16 offset:2048
    s_waitcnt lgkmcnt(8)
    v_mfma_f32_16x16x32_bf16 v[24:27], v[192:195], v[64:67], v[24:27]
    ds_read_b128 v[60:63], v19 offset:33792
    v_mfma_f32_16x16x32_bf16 v[28:31], v[196:199], v[64:67], v[28:31]
    ds_read_b64_tr_b16 v[232:233], v13 offset:36864
    s_waitcnt lgkmcnt(9)
    v_mfma_f32_16x16x32_bf16 v[32:35], v[192:195], v[68:71], v[32:35]
    ds_read_b128 v[64:67], v19 offset:34816
    v_mfma_f32_16x16x32_bf16 v[36:39], v[196:199], v[68:71], v[36:39]
    ds_read_b64_tr_b16 v[234:235], v13 offset:38912
    s_waitcnt lgkmcnt(9)
    v_mfma_f32_16x16x32_bf16 v[40:43], v[192:195], v[72:75], v[40:43]
    ds_read_b128 v[68:71], v19 offset:35840
    v_mfma_f32_16x16x32_bf16 v[44:47], v[196:199], v[72:75], v[44:47]
    ds_read_b64_tr_b16 v[236:237], v16 offset:36864
    s_waitcnt lgkmcnt(9)
    v_mfma_f32_16x16x32_bf16 v[48:51], v[192:195], v[76:79], v[48:51]
    s_barrier
    ds_read_b128 v[72:75], v20 offset:0
    v_mfma_f32_16x16x32_bf16 v[52:55], v[196:199], v[76:79], v[52:55]
    ds_read_b64_tr_b16 v[238:239], v16 offset:38912
    s_waitcnt lgkmcnt(9)
    v_mfma_f32_16x16x32_bf16 v[24:27], v[200:203], v[56:59], v[24:27]
    ds_read_b128 v[76:79], v20 offset:1024
    v_mfma_f32_16x16x32_bf16 v[28:31], v[204:207], v[56:59], v[28:31]
    ds_read_b64_tr_b16 v[240:241], v14 offset:16384
    s_waitcnt lgkmcnt(9)
    v_mfma_f32_16x16x32_bf16 v[32:35], v[200:203], v[60:63], v[32:35]
    ds_read_b128 v[56:59], v20 offset:2048
    v_mfma_f32_16x16x32_bf16 v[36:39], v[204:207], v[60:63], v[36:39]
    ds_read_b64_tr_b16 v[242:243], v14 offset:18432
    s_waitcnt lgkmcnt(9)
    v_mfma_f32_16x16x32_bf16 v[40:43], v[200:203], v[64:67], v[40:43]
    ds_read_b128 v[60:63], v20 offset:3072
    v_mfma_f32_16x16x32_bf16 v[44:47], v[204:207], v[64:67], v[44:47]
    ds_read_b64_tr_b16 v[244:245], v17 offset:16384
    s_waitcnt lgkmcnt(9)
    v_mfma_f32_16x16x32_bf16 v[48:51], v[200:203], v[68:71], v[48:51]
    ds_read_b128 v[64:67], v19 offset:49152
    v_mfma_f32_16x16x32_bf16 v[52:55], v[204:207], v[68:71], v[52:55]
    ds_read_b64_tr_b16 v[246:247], v17 offset:18432
    s_waitcnt lgkmcnt(9)
    v_mfma_f32_16x16x32_bf16 v[24:27], v[208:211], v[72:75], v[24:27]
    ds_read_b128 v[68:71], v19 offset:50176
    v_mfma_f32_16x16x32_bf16 v[28:31], v[212:215], v[72:75], v[28:31]
    ds_read_b64_tr_b16 v[248:249], v13 offset:4096
    s_waitcnt lgkmcnt(9)
    v_mfma_f32_16x16x32_bf16 v[32:35], v[208:211], v[76:79], v[32:35]
    ds_read_b128 v[72:75], v19 offset:51200
    v_mfma_f32_16x16x32_bf16 v[36:39], v[212:215], v[76:79], v[36:39]
    ds_read_b64_tr_b16 v[250:251], v13 offset:6144
    s_waitcnt lgkmcnt(9)
    v_mfma_f32_16x16x32_bf16 v[40:43], v[208:211], v[56:59], v[40:43]
    ds_read_b128 v[76:79], v19 offset:52224
    v_mfma_f32_16x16x32_bf16 v[44:47], v[212:215], v[56:59], v[44:47]
    ds_read_b64_tr_b16 v[252:253], v16 offset:4096
    s_waitcnt lgkmcnt(9)
    v_mfma_f32_16x16x32_bf16 v[48:51], v[208:211], v[60:63], v[48:51]
    ds_read_b128 v[56:59], v19 offset:53248
    v_mfma_f32_16x16x32_bf16 v[52:55], v[212:215], v[60:63], v[52:55]
    ds_read_b64_tr_b16 v[254:255], v16 offset:6144
    s_waitcnt lgkmcnt(9)
    v_mfma_f32_16x16x32_bf16 v[24:27], v[216:219], v[64:67], v[24:27]
    ds_read_b128 v[60:63], v19 offset:54272
    v_mfma_f32_16x16x32_bf16 v[28:31], v[220:223], v[64:67], v[28:31]
    ds_read_b64_tr_b16 v[80:81], v13 offset:16384
    s_waitcnt lgkmcnt(9)
    v_mfma_f32_16x16x32_bf16 v[32:35], v[216:219], v[68:71], v[32:35]
    ds_read_b128 v[64:67], v19 offset:55296
    v_mfma_f32_16x16x32_bf16 v[36:39], v[220:223], v[68:71], v[36:39]
    ds_read_b64_tr_b16 v[82:83], v13 offset:18432
    s_waitcnt lgkmcnt(9)
    v_mfma_f32_16x16x32_bf16 v[40:43], v[216:219], v[72:75], v[40:43]
    ds_read_b128 v[68:71], v19 offset:56320
    v_mfma_f32_16x16x32_bf16 v[44:47], v[220:223], v[72:75], v[44:47]
    ds_read_b64_tr_b16 v[84:85], v16 offset:16384
    s_waitcnt lgkmcnt(9)
    v_mfma_f32_16x16x32_bf16 v[48:51], v[216:219], v[76:79], v[48:51]
    s_barrier
    ds_read_b128 v[72:75], v20 offset:32768
    v_mfma_f32_16x16x32_bf16 v[52:55], v[220:223], v[76:79], v[52:55]
    ds_read_b64_tr_b16 v[86:87], v16 offset:18432
    s_waitcnt lgkmcnt(9)
    v_mfma_f32_16x16x32_bf16 v[24:27], v[224:227], v[56:59], v[24:27]
    ds_read_b128 v[76:79], v20 offset:33792
    v_mfma_f32_16x16x32_bf16 v[28:31], v[228:231], v[56:59], v[28:31]
    ds_read_b64_tr_b16 v[88:89], v14 offset:20480
    s_waitcnt lgkmcnt(9)
    v_mfma_f32_16x16x32_bf16 v[32:35], v[224:227], v[60:63], v[32:35]
    ds_read_b128 v[56:59], v20 offset:34816
    v_mfma_f32_16x16x32_bf16 v[36:39], v[228:231], v[60:63], v[36:39]
    ds_read_b64_tr_b16 v[90:91], v14 offset:22528
    s_waitcnt lgkmcnt(9)
    v_mfma_f32_16x16x32_bf16 v[40:43], v[224:227], v[64:67], v[40:43]
    ds_read_b128 v[60:63], v20 offset:35840
    v_mfma_f32_16x16x32_bf16 v[44:47], v[228:231], v[64:67], v[44:47]
    ds_read_b64_tr_b16 v[92:93], v17 offset:20480
    s_waitcnt lgkmcnt(9)
    v_mfma_f32_16x16x32_bf16 v[48:51], v[224:227], v[68:71], v[48:51]
    ds_read_b128 v[64:67], v21 offset:0
    v_mfma_f32_16x16x32_bf16 v[52:55], v[228:231], v[68:71], v[52:55]
    ds_read_b64_tr_b16 v[94:95], v17 offset:22528
    s_waitcnt lgkmcnt(9)
    v_mfma_f32_16x16x32_bf16 v[24:27], v[232:235], v[72:75], v[24:27]
    ds_read_b128 v[68:71], v21 offset:1024
    v_mfma_f32_16x16x32_bf16 v[28:31], v[236:239], v[72:75], v[28:31]
    ds_read_b64_tr_b16 v[96:97], v14 offset:4096
    s_waitcnt lgkmcnt(9)
    v_mfma_f32_16x16x32_bf16 v[32:35], v[232:235], v[76:79], v[32:35]
    ds_read_b128 v[72:75], v21 offset:2048
    v_mfma_f32_16x16x32_bf16 v[36:39], v[236:239], v[76:79], v[36:39]
    ds_read_b64_tr_b16 v[98:99], v14 offset:6144
    s_waitcnt lgkmcnt(9)
    v_mfma_f32_16x16x32_bf16 v[40:43], v[232:235], v[56:59], v[40:43]
    ds_read_b128 v[76:79], v21 offset:3072
    v_mfma_f32_16x16x32_bf16 v[44:47], v[236:239], v[56:59], v[44:47]
    ds_read_b64_tr_b16 v[100:101], v17 offset:4096
    s_waitcnt lgkmcnt(9)
    v_mfma_f32_16x16x32_bf16 v[48:51], v[232:235], v[60:63], v[48:51]
    ds_read_b128 v[56:59], v20 offset:53248
    v_mfma_f32_16x16x32_bf16 v[52:55], v[236:239], v[60:63], v[52:55]
    ds_read_b64_tr_b16 v[102:103], v17 offset:6144
    s_waitcnt lgkmcnt(9)
    v_mfma_f32_16x16x32_bf16 v[24:27], v[240:243], v[64:67], v[24:27]
    ds_read_b128 v[60:63], v20 offset:54272
    v_mfma_f32_16x16x32_bf16 v[28:31], v[244:247], v[64:67], v[28:31]
    ds_read_b64_tr_b16 v[104:105], v14 offset:36864
    s_waitcnt lgkmcnt(9)
    v_mfma_f32_16x16x32_bf16 v[32:35], v[240:243], v[68:71], v[32:35]
    ds_read_b128 v[64:67], v20 offset:55296
    v_mfma_f32_16x16x32_bf16 v[36:39], v[244:247], v[68:71], v[36:39]
    ds_read_b64_tr_b16 v[106:107], v14 offset:38912
    s_waitcnt lgkmcnt(9)
    v_mfma_f32_16x16x32_bf16 v[40:43], v[240:243], v[72:75], v[40:43]
    ds_read_b128 v[68:71], v20 offset:56320
    v_mfma_f32_16x16x32_bf16 v[44:47], v[244:247], v[72:75], v[44:47]
    ds_read_b64_tr_b16 v[108:109], v17 offset:36864
    s_waitcnt lgkmcnt(9)
    v_mfma_f32_16x16x32_bf16 v[48:51], v[240:243], v[76:79], v[48:51]
    s_barrier
    ds_read_b128 v[72:75], v21 offset:4096
    v_mfma_f32_16x16x32_bf16 v[52:55], v[244:247], v[76:79], v[52:55]
    ds_read_b64_tr_b16 v[110:111], v17 offset:38912
    s_waitcnt lgkmcnt(9)
    v_mfma_f32_16x16x32_bf16 v[24:27], v[248:251], v[56:59], v[24:27]
    ds_read_b128 v[76:79], v21 offset:5120
    v_mfma_f32_16x16x32_bf16 v[28:31], v[252:255], v[56:59], v[28:31]
    ds_read_b64_tr_b16 v[112:113], v14 offset:49152
    s_waitcnt lgkmcnt(9)
    v_mfma_f32_16x16x32_bf16 v[32:35], v[248:251], v[60:63], v[32:35]
    ds_read_b128 v[56:59], v21 offset:6144
    v_mfma_f32_16x16x32_bf16 v[36:39], v[252:255], v[60:63], v[36:39]
    ds_read_b64_tr_b16 v[114:115], v14 offset:51200
    s_waitcnt lgkmcnt(9)
    v_mfma_f32_16x16x32_bf16 v[40:43], v[248:251], v[64:67], v[40:43]
    ds_read_b128 v[60:63], v21 offset:7168
    v_mfma_f32_16x16x32_bf16 v[44:47], v[252:255], v[64:67], v[44:47]
    ds_read_b64_tr_b16 v[116:117], v17 offset:49152
    s_waitcnt lgkmcnt(9)
    v_mfma_f32_16x16x32_bf16 v[48:51], v[248:251], v[68:71], v[48:51]
    s_barrier
    ds_read_b128 v[64:67], v21 offset:16384
    v_mfma_f32_16x16x32_bf16 v[52:55], v[252:255], v[68:71], v[52:55]
    ds_read_b64_tr_b16 v[118:119], v17 offset:51200
    s_waitcnt lgkmcnt(9)
    v_mfma_f32_16x16x32_bf16 v[24:27], v[80:83], v[72:75], v[24:27]
    ds_read_b128 v[68:71], v21 offset:17408
    v_mfma_f32_16x16x32_bf16 v[28:31], v[84:87], v[72:75], v[28:31]
    ds_read_b64_tr_b16 v[120:121], v13 offset:20480
    s_waitcnt lgkmcnt(9)
    v_mfma_f32_16x16x32_bf16 v[32:35], v[80:83], v[76:79], v[32:35]
    ds_read_b128 v[72:75], v21 offset:18432
    v_mfma_f32_16x16x32_bf16 v[36:39], v[84:87], v[76:79], v[36:39]
    ds_read_b64_tr_b16 v[122:123], v13 offset:22528
    s_waitcnt lgkmcnt(9)
    v_mfma_f32_16x16x32_bf16 v[40:43], v[80:83], v[56:59], v[40:43]
    ds_read_b128 v[76:79], v21 offset:19456
    v_mfma_f32_16x16x32_bf16 v[44:47], v[84:87], v[56:59], v[44:47]
    ds_read_b64_tr_b16 v[124:125], v16 offset:20480
    s_waitcnt lgkmcnt(9)
    v_mfma_f32_16x16x32_bf16 v[48:51], v[80:83], v[60:63], v[48:51]
    s_barrier
    ds_read_b128 v[56:59], v21 offset:20480
    v_mfma_f32_16x16x32_bf16 v[52:55], v[84:87], v[60:63], v[52:55]
    ds_read_b64_tr_b16 v[126:127], v16 offset:22528
    s_waitcnt lgkmcnt(9)
    v_mfma_f32_16x16x32_bf16 v[24:27], v[88:91], v[64:67], v[24:27]
    ds_read_b128 v[60:63], v21 offset:21504
    v_mfma_f32_16x16x32_bf16 v[28:31], v[92:95], v[64:67], v[28:31]
    s_waitcnt lgkmcnt(8)
    v_mfma_f32_16x16x32_bf16 v[32:35], v[88:91], v[68:71], v[32:35]
    ds_read_b128 v[64:67], v21 offset:22528
    v_mfma_f32_16x16x32_bf16 v[36:39], v[92:95], v[68:71], v[36:39]
    s_waitcnt lgkmcnt(7)
    v_mfma_f32_16x16x32_bf16 v[40:43], v[88:91], v[72:75], v[40:43]
    ds_read_b128 v[68:71], v21 offset:23552
    v_mfma_f32_16x16x32_bf16 v[44:47], v[92:95], v[72:75], v[44:47]
    s_waitcnt lgkmcnt(6)
    v_mfma_f32_16x16x32_bf16 v[48:51], v[88:91], v[76:79], v[48:51]
    s_barrier
    ds_read_b128 v[72:75], v19 offset:0
    v_mfma_f32_16x16x32_bf16 v[52:55], v[92:95], v[76:79], v[52:55]
    s_waitcnt lgkmcnt(5)
    v_mfma_f32_16x16x32_bf16 v[24:27], v[96:99], v[56:59], v[24:27]
    ds_read_b128 v[76:79], v19 offset:1024
    v_mfma_f32_16x16x32_bf16 v[28:31], v[100:103], v[56:59], v[28:31]
    s_waitcnt lgkmcnt(4)
    v_mfma_f32_16x16x32_bf16 v[32:35], v[96:99], v[60:63], v[32:35]
    ds_read_b128 v[56:59], v19 offset:2048
    v_mfma_f32_16x16x32_bf16 v[36:39], v[100:103], v[60:63], v[36:39]
    s_waitcnt lgkmcnt(4)
    v_mfma_f32_16x16x32_bf16 v[40:43], v[96:99], v[64:67], v[40:43]
    ds_read_b128 v[60:63], v19 offset:3072
    v_mfma_f32_16x16x32_bf16 v[44:47], v[100:103], v[64:67], v[44:47]
    s_waitcnt lgkmcnt(4)
    v_mfma_f32_16x16x32_bf16 v[48:51], v[96:99], v[68:71], v[48:51]
    s_barrier
    ds_read_b128 v[64:67], v19 offset:51200
    v_mfma_f32_16x16x32_bf16 v[52:55], v[100:103], v[68:71], v[52:55]
    s_waitcnt lgkmcnt(4)
    v_mfma_f32_16x16x32_bf16 v[24:27], v[104:107], v[72:75], v[24:27]
    ds_read_b128 v[68:71], v19 offset:52224
    v_mfma_f32_16x16x32_bf16 v[28:31], v[108:111], v[72:75], v[28:31]
    s_waitcnt lgkmcnt(4)
    v_mfma_f32_16x16x32_bf16 v[32:35], v[104:107], v[76:79], v[32:35]
    ds_read_b128 v[72:75], v20 offset:2048
    v_mfma_f32_16x16x32_bf16 v[36:39], v[108:111], v[76:79], v[36:39]
    s_waitcnt lgkmcnt(4)
    v_mfma_f32_16x16x32_bf16 v[40:43], v[104:107], v[56:59], v[40:43]
    ds_read_b128 v[76:79], v20 offset:3072
    v_mfma_f32_16x16x32_bf16 v[44:47], v[108:111], v[56:59], v[44:47]
    s_waitcnt lgkmcnt(4)
    v_mfma_f32_16x16x32_bf16 v[48:51], v[104:107], v[60:63], v[48:51]
    ds_read_b128 v[56:59], v19 offset:49152
    v_mfma_f32_16x16x32_bf16 v[52:55], v[108:111], v[60:63], v[52:55]
    s_waitcnt lgkmcnt(4)
    v_mfma_f32_16x16x32_bf16 v[40:43], v[112:115], v[64:67], v[40:43]
    ds_read_b128 v[60:63], v19 offset:50176
    v_mfma_f32_16x16x32_bf16 v[44:47], v[116:119], v[64:67], v[44:47]
    s_waitcnt lgkmcnt(4)
    v_mfma_f32_16x16x32_bf16 v[48:51], v[112:115], v[68:71], v[48:51]
    ds_read_b128 v[64:67], v20 offset:0
    v_mfma_f32_16x16x32_bf16 v[52:55], v[116:119], v[68:71], v[52:55]
    s_waitcnt lgkmcnt(4)
    v_mfma_f32_16x16x32_bf16 v[40:43], v[120:123], v[72:75], v[40:43]
    ds_read_b128 v[68:71], v20 offset:1024
    v_mfma_f32_16x16x32_bf16 v[44:47], v[124:127], v[72:75], v[44:47]
    s_add_u32 s26, s26, 16384
    v_add_u32 v2, s26, v12
    v_xor_b32 v3, 0x2000, v2
    s_waitcnt lgkmcnt(4)
    v_mfma_f32_16x16x32_bf16 v[48:51], v[120:123], v[76:79], v[48:51]
    v_mfma_f32_16x16x32_bf16 v[52:55], v[124:127], v[76:79], v[52:55]
    s_waitcnt lgkmcnt(3)
    v_mfma_f32_16x16x32_bf16 v[24:27], v[112:115], v[56:59], v[24:27]
    v_mfma_f32_16x16x32_bf16 v[28:31], v[116:119], v[56:59], v[28:31]
    s_waitcnt lgkmcnt(2)
    v_mfma_f32_16x16x32_bf16 v[32:35], v[112:115], v[60:63], v[32:35]
    v_mfma_f32_16x16x32_bf16 v[36:39], v[116:119], v[60:63], v[36:39]
    s_nop 2
    ds_write_b128 v2, v[40:43] offset:0
    ds_write_b128 v2, v[44:47] offset:1024
    s_waitcnt lgkmcnt(3)
    v_mfma_f32_16x16x32_bf16 v[24:27], v[120:123], v[64:67], v[24:27]
    v_mfma_f32_16x16x32_bf16 v[28:31], v[124:127], v[64:67], v[28:31]
    ds_write_b128 v2, v[48:51] offset:2048
    ds_write_b128 v2, v[52:55] offset:3072
    s_waitcnt lgkmcnt(4)
    v_mfma_f32_16x16x32_bf16 v[32:35], v[120:123], v[68:71], v[32:35]
    v_mfma_f32_16x16x32_bf16 v[36:39], v[124:127], v[68:71], v[36:39]
    s_waitcnt lgkmcnt(0)
    s_barrier
    ds_read_b128 v[56:59], v3 offset:0
    ds_read_b128 v[60:63], v3 offset:1024
    ds_read_b128 v[64:67], v3 offset:2048
    ds_read_b128 v[68:71], v3 offset:3072
    s_nop 2
    s_waitcnt lgkmcnt(3)
    v_add_f32 v56, v56, v24
    v_add_f32 v57, v57, v25
    v_add_f32 v58, v58, v26
    v_add_f32 v59, v59, v27
    v_cvt_pk_bf16_f32 v72, v56, v57
    v_cvt_pk_bf16_f32 v73, v58, v59
    s_waitcnt lgkmcnt(2)
    v_add_f32 v60, v60, v28
    v_add_f32 v61, v61, v29
    v_add_f32 v62, v62, v30
    v_add_f32 v63, v63, v31
    v_cvt_pk_bf16_f32 v74, v60, v61
    v_cvt_pk_bf16_f32 v75, v62, v63
    s_nop 1
    v_permlane16_swap_b32 v72, v74
    v_permlane16_swap_b32 v73, v75
    buffer_store_dwordx4 v[72:75], v22, s[60:63], s25 offen

    s_waitcnt lgkmcnt(1)
    v_add_f32 v64, v64, v32
    v_add_f32 v65, v65, v33
    v_add_f32 v66, v66, v34
    v_add_f32 v67, v67, v35
    v_cvt_pk_bf16_f32 v76, v64, v65
    v_cvt_pk_bf16_f32 v77, v66, v67
    s_waitcnt lgkmcnt(0)
    v_add_f32 v68, v68, v36
    v_add_f32 v69, v69, v37
    v_add_f32 v70, v70, v38
    v_add_f32 v71, v71, v39
    v_cvt_pk_bf16_f32 v78, v68, v69
    v_cvt_pk_bf16_f32 v79, v70, v71
    s_nop 1
    v_permlane16_swap_b32 v76, v78
    v_permlane16_swap_b32 v77, v79
    buffer_store_dwordx4 v[76:79], v23, s[60:63], s25 offen

L_end:
    s_endpgm
L_slS0:
    s_mov_b32 s71, 0
    v_mov_b32 v0, 0
L_tgS0:
    buffer_load_dwordx2 v[2:3], v0, s[36:39], 0 offen sc1
    s_add_u32 s71, s71, 1
    s_waitcnt vmcnt(0)
    v_readfirstlane_b32 s74, v2
    v_readfirstlane_b32 s75, v3
    s_cmp_gt_u32 s71, 200000
    s_cbranch_scc1 L_ckS0
    s_cmp_eq_u32 s75, 0
    s_cbranch_scc0 L_ckS0
    s_sleep 4
    s_branch L_tgS0
L_gs0:
    s_barrier
    s_mov_b32 s71, 0
L_gp0:
    s_load_dwordx16 s[0:15], s[72:73], 0 glc
    s_add_u32 s71, s71, 1
    s_waitcnt lgkmcnt(0)
    s_cmp_gt_u32 s71, 200000
    s_cbranch_scc1 L_go0
    s_xor_b64 s[0:1], s[0:1], s[74:75]
    s_xor_b64 s[2:3], s[2:3], s[74:75]
    s_xor_b64 s[4:5], s[4:5], s[74:75]
    s_xor_b64 s[6:7], s[6:7], s[74:75]
    s_xor_b64 s[8:9], s[8:9], s[74:75]
    s_xor_b64 s[10:11], s[10:11], s[74:75]
    s_xor_b64 s[12:13], s[12:13], s[74:75]
    s_or_b64 s[0:1], s[0:1], s[2:3]
    s_or_b64 s[0:1], s[0:1], s[4:5]
    s_or_b64 s[0:1], s[0:1], s[6:7]
    s_or_b64 s[0:1], s[0:1], s[8:9]
    s_or_b64 s[0:1], s[0:1], s[10:11]
    s_or_b64 s[0:1], s[0:1], s[12:13]
    s_cbranch_scc1 L_gp0
L_go0:

    s_add_u32 m0, s27, 20480
    s_add_u32 s68, s44, 0
    buffer_load_dwordx4 v12, s[32:35], s68 offen sc1 lds
    buffer_load_dwordx4 v12, s[32:35], s68 offen offset:1024 sc1 lds
    s_add_u32 m0, s27, 32768
    s_add_u32 s68, s45, 0
    buffer_load_dwordx4 v12, s[32:35], s68 offen sc1 lds
    buffer_load_dwordx4 v12, s[32:35], s68 offen offset:1024 sc1 lds
    s_add_u32 m0, s27, 49152
    s_add_u32 s68, s46, 0
    buffer_load_dwordx4 v12, s[32:35], s68 offen sc1 lds
    buffer_load_dwordx4 v12, s[32:35], s68 offen offset:1024 sc1 lds
    s_add_u32 m0, s27, 53248
    s_add_u32 s68, s47, 0
    buffer_load_dwordx4 v12, s[32:35], s68 offen sc1 lds
    buffer_load_dwordx4 v12, s[32:35], s68 offen offset:1024 sc1 lds
    s_branch L_gf0
L_gs1:
    s_waitcnt vmcnt(2)
    s_barrier
    s_mov_b32 s71, 0
L_gp1:
    s_load_dwordx16 s[0:15], s[72:73], 64 glc
    s_add_u32 s71, s71, 1
    s_waitcnt lgkmcnt(0)
    s_cmp_gt_u32 s71, 200000
    s_cbranch_scc1 L_go1
    s_xor_b64 s[0:1], s[0:1], s[74:75]
    s_xor_b64 s[2:3], s[2:3], s[74:75]
    s_xor_b64 s[4:5], s[4:5], s[74:75]
    s_xor_b64 s[6:7], s[6:7], s[74:75]
    s_xor_b64 s[8:9], s[8:9], s[74:75]
    s_xor_b64 s[10:11], s[10:11], s[74:75]
    s_xor_b64 s[12:13], s[12:13], s[74:75]
    s_or_b64 s[0:1], s[0:1], s[2:3]
    s_or_b64 s[0:1], s[0:1], s[4:5]
    s_or_b64 s[0:1], s[0:1], s[6:7]
    s_or_b64 s[0:1], s[0:1], s[8:9]
    s_or_b64 s[0:1], s[0:1], s[10:11]
    s_or_b64 s[0:1], s[0:1], s[12:13]
    s_cbranch_scc1 L_gp1
L_go1:

    s_add_u32 m0, s27, 102400
    s_add_u32 s68, s44, 2048
    buffer_load_dwordx4 v12, s[32:35], s68 offen sc1 lds
    buffer_load_dwordx4 v12, s[32:35], s68 offen offset:1024 sc1 lds
    s_add_u32 m0, s27, 114688
    s_add_u32 s68, s45, 2048
    buffer_load_dwordx4 v12, s[32:35], s68 offen sc1 lds
    buffer_load_dwordx4 v12, s[32:35], s68 offen offset:1024 sc1 lds
    s_add_u32 m0, s27, 118784
    s_add_u32 s68, s46, 2048
    buffer_load_dwordx4 v12, s[32:35], s68 offen sc1 lds
    buffer_load_dwordx4 v12, s[32:35], s68 offen offset:1024 sc1 lds
    s_add_u32 m0, s27, 131072
    s_add_u32 s68, s47, 2048
    buffer_load_dwordx4 v12, s[32:35], s68 offen sc1 lds
    buffer_load_dwordx4 v12, s[32:35], s68 offen offset:1024 sc1 lds
    s_add_u32 m0, s27, 135168
    s_add_u32 s68, s48, 2048
    buffer_load_dwordx4 v12, s[32:35], s68 offen sc1 lds
    buffer_load_dwordx4 v12, s[32:35], s68 offen offset:1024 sc1 lds
    s_branch L_gf1
L_pref:
    s_sub_u32 s42, s42, 28
    v_lshlrev_b32 v9, 4, v2
    s_lshl_b32 s42, s42, 3
    s_add_u32 s42, s42, s40
    s_mov_b32 s48, 0
    s_mul_i32 s50, s41, 49
    s_waitcnt lgkmcnt(0)
    s_mov_b32 s28, s10
    s_mov_b32 s29, s11
    s_mov_b32 s30, 1605632
    s_mov_b32 s31, 0x20000

    s_waitcnt vmcnt(0)
    buffer_load_dwordx4 v[20:23], v9, s[28:31], s50 offen
    s_waitcnt vmcnt(0)
    s_and_b32 s44, s41, 1
    s_mul_i32 s44, s44, 1792
    s_add_u32 s44, s44, 128
    s_and_b32 s45, s42, 1
    s_cmp_eq_u32 s45, 0
    s_cselect_b32 s20, s6, s8
    s_cselect_b32 s21, s7, s9
    s_mov_b32 s22, 1605632
    s_mov_b32 s23, 0x20000
    v_lshrrev_b32 v3, 3, v2
    v_and_b32 v4, 7, v2
    v_mul_u32_u24 v3, 3584, v3
    v_lshl_add_u32 v3, v4, 4, v3
    s_lshr_b32 s49, s42, 1
    s_lshr_b32 s51, s41, 1
    s_mul_i32 s51, s51, 98

L_pf1:
    s_add_u32 s52, s49, s51
    s_cmp_ge_u32 s52, 392
    s_cselect_b32 s53, 392, 0
    s_sub_u32 s52, s52, s53
    s_mul_hi_u32 s45, s52, 613566757
    s_mul_i32 s46, s45, 26880
    s_lshl_b32 s47, s52, 8
    s_add_u32 s47, s47, s46
    s_add_u32 s47, s47, s44
    buffer_load_dwordx4 v[20:23], v3, s[20:23], s47 offen
    s_add_u32 s49, s49, 16
    s_cmp_lt_u32 s49, 98
    s_cbranch_scc1 L_pf1

    s_barrier
    s_lshl_b32 s52, s41, 5
    s_add_u32 s52, s52, s42
    s_mul_i32 s52, s52, 6272

    buffer_load_dwordx4 v[20:23], v9, s[28:31], s52 offen
    s_add_u32 s52, s52, 1024
    buffer_load_dwordx4 v[20:23], v9, s[28:31], s52 offen
    s_add_u32 s52, s52, 1024
    buffer_load_dwordx4 v[20:23], v9, s[28:31], s52 offen
    s_add_u32 s52, s52, 1024
    buffer_load_dwordx4 v[20:23], v9, s[28:31], s52 offen
    s_add_u32 s52, s52, 1024
    buffer_load_dwordx4 v[20:23], v9, s[28:31], s52 offen
    s_add_u32 s52, s52, 1024
    buffer_load_dwordx4 v[20:23], v9, s[28:31], s52 offen
    s_add_u32 s52, s52, 128
    buffer_load_dwordx4 v[20:23], v9, s[28:31], s52 offen
    s_add_u32 s52, s52, 128
    s_barrier
    s_endpgm
L_pf2:
    s_mov_b32 s49, s42
L_pf3:
    s_add_u32 s52, s49, s50
    s_cmp_ge_u32 s52, 392
    s_cselect_b32 s53, 392, 0
    s_sub_u32 s52, s52, s53
    s_mul_hi_u32 s45, s52, 153391690
    s_mul_i32 s46, s45, 86016
    s_lshl_b32 s47, s52, 10
    s_add_u32 s47, s47, s46
    s_add_u32 s47, s47, s48
    s_waitcnt vmcnt(8)
    buffer_load_dwordx4 v[20:23], v9, s[28:31], s47 offen
    s_add_u32 s49, s49, 32
    s_cmp_lt_u32 s49, 392
    s_cbranch_scc1 L_pf3
    s_add_u32 s48, s48, 28672
    s_cmp_lt_u32 s48, 0
    s_cbranch_scc1 L_pf2
L_pfx:
    s_endpgm
L_c:
    s_setprio 3
    s_memrealtime s[64:65]
    v_and_b32 v3, 15, v2
    v_lshrrev_b32 v4, 4, v2
    s_lshl_b32 s71, s50, 5
    v_add_u32 v5, s71, v3
    v_bfe_u32 v6, v5, 1, 3
    v_xor_b32 v6, v6, v4
    v_lshlrev_b32 v6, 4, v6
    v_lshl_add_u32 v1, v5, 7, v6
    v_bfe_u32 v5, v2, 2, 2
    v_and_b32 v8, 3, v2
    v_lshlrev_b32 v8, 3, v8
    v_lshl_add_u32 v8, v5, 7, v8
    v_lshrrev_b32 v7, 1, v5
    v_and_b32 v6, 1, v4
    v_lshl_add_u32 v6, v7, 1, v6
    v_lshl_add_u32 v3, v6, 5, v8
    v_lshl_add_u32 v3, v4, 10, v3
    v_lshlrev_b32 v9, 4, v2
    v_add_u32 v11, 4096, v9
    s_lshl_b32 s66, s47, 2
    s_add_u32 s66, s66, s50
    s_mul_i32 s71, s66, 14
    s_add_u32 s71, s71, s48
    s_lshl_b32 s54, s71, 13
    s_lshl_b32 s66, s66, 1
    s_and_b32 s71, s48, 1
    s_add_u32 s66, s66, s71
    s_lshl_b32 s66, s66, 8
    s_lshr_b32 s71, s48, 1
    s_lshl_b32 s71, s71, 3
    s_add_u32 s66, s66, s71
    s_add_u32 s66, s66, 8388608
    v_lshlrev_b32 v14, 17, v2
    v_add_u32 v14, s66, v14
    s_mov_b32 s59, 0xbfb8aa3b
    s_add_u32 s67, s2, s50
    s_and_b32 s26, s50, 0
    s_waitcnt lgkmcnt(0)

    s_lshl_b32 s55, s43, 3
    s_lshl_b32 s71, s51, 2
    s_add_u32 s55, s55, s71
    s_add_u32 s55, s55, s52
    s_lshl_b32 s58, s55, 1
    s_add_u32 s58, s58, s56
    s_mul_i32 s70, s58, 14
    s_add_u32 s70, s70, s57
    s_lshl_b32 s70, s70, 13
    s_lshl_b32 s71, s58, 1
    s_add_u32 s71, s71, s57
    s_lshl_b32 s71, s71, 8
    s_add_u32 s71, s71, 8388608
    s_add_u32 s72, s76, s71
    s_addc_u32 s73, s77, 0
    s_lshl_b32 s66, s57, 3
    s_add_u32 s66, s66, s56
    s_mul_i32 s66, s66, 14336
    s_lshl_b32 s71, s53, 7
    s_add_u32 s66, s66, s71
    s_mul_i32 s71, s70, 14
    s_sub_u32 s66, s66, s71

    s_lshl_b32 s44, s79, 14
    s_add_u32 s44, s44, s70
    s_add_u32 s79, s79, 1
    s_cmp_eq_u32 s79, 7
    s_cselect_b32 s79, 0, s79
    s_lshl_b32 s45, s79, 14
    s_add_u32 s45, s45, s70
    s_add_u32 s79, s79, 1
    s_cmp_eq_u32 s79, 7
    s_cselect_b32 s79, 0, s79
    s_lshl_b32 s46, s79, 14
    s_add_u32 s46, s46, s70
    s_add_u32 s79, s79, 1
    s_cmp_eq_u32 s79, 7
    s_cselect_b32 s79, 0, s79
    s_lshl_b32 s47, s79, 14
    s_add_u32 s47, s47, s70
    s_add_u32 s79, s79, 1
    s_cmp_eq_u32 s79, 7
    s_cselect_b32 s79, 0, s79
    s_lshl_b32 s48, s79, 14
    s_add_u32 s48, s48, s70
    s_add_u32 s79, s79, 1
    s_cmp_eq_u32 s79, 7
    s_cselect_b32 s79, 0, s79
    s_lshl_b32 s49, s79, 14
    s_add_u32 s49, s49, s70
    s_add_u32 s79, s79, 1
    s_cmp_eq_u32 s79, 7
    s_cselect_b32 s79, 0, s79
    s_lshl_b32 s50, s79, 14
    s_add_u32 s50, s50, s70
    s_add_u32 s79, s79, 1
    s_cmp_eq_u32 s79, 7
    s_cselect_b32 s79, 0, s79
    s_mov_b32 s32, s76
    s_mov_b32 s33, s77
    s_mov_b32 s34, 268435456
    s_mov_b32 s35, 0x20000

    s_mov_b32 s36, s14
    s_mov_b32 s37, s15
    s_mov_b32 s38, 256
    s_mov_b32 s39, 0x20000

    s_mov_b32 s28, s10
    s_mov_b32 s29, s11
    s_mov_b32 s30, 1605632
    s_mov_b32 s31, 0x20000

    v_mov_b32 v0, 0
    s_cmp_lg_u32 s67, 0
    s_cbranch_scc1 L_notag
    s_or_b32 s65, s65, 0x80000000
    v_mov_b32 v12, s64
    v_mov_b32 v13, s65
    s_mov_b64 exec, 1
    buffer_store_dwordx2 v[12:13], v0, s[36:39], 0 offen sc0 sc1
    s_mov_b64 exec, -1
L_notag:
    s_barrier
    v_xor_b32 v2, 0, v1
    ds_read_b128 v[16:19], v2 offset:0
    ds_read_b128 v[20:23], v2 offset:2048
    v_xor_b32 v4, 16384, v3
    ds_read_b64_tr_b16 v[224:225], v4 offset:0
    ds_read_b64_tr_b16 v[226:227], v4 offset:512
    ds_read_b64_tr_b16 v[228:229], v4 offset:8192
    ds_read_b64_tr_b16 v[230:231], v4 offset:8704
    v_xor_b32 v5, 16416, v3
    ds_read_b64_tr_b16 v[232:233], v5 offset:0
    ds_read_b64_tr_b16 v[234:235], v5 offset:512
    ds_read_b64_tr_b16 v[236:237], v5 offset:8192
    ds_read_b64_tr_b16 v[238:239], v5 offset:8704
    v_xor_b32 v6, 16448, v3
    ds_read_b64_tr_b16 v[240:241], v6 offset:0
    ds_read_b64_tr_b16 v[242:243], v6 offset:512
    ds_read_b64_tr_b16 v[244:245], v6 offset:8192
    ds_read_b64_tr_b16 v[246:247], v6 offset:8704
    v_xor_b32 v7, 16480, v3
    ds_read_b64_tr_b16 v[248:249], v7 offset:0
    s_waitcnt lgkmcnt(14)
    ds_read_b64_tr_b16 v[250:251], v7 offset:512
    s_waitcnt lgkmcnt(10)
    v_mfma_f32_16x16x32_bf16 v[128:131], v[224:227], v[16:19], 0
    ds_read_b64_tr_b16 v[252:253], v7 offset:8192
    v_mfma_f32_16x16x32_bf16 v[136:139], v[224:227], v[20:23], 0
    ds_read_b64_tr_b16 v[254:255], v7 offset:8704
    v_mfma_f32_16x16x32_bf16 v[144:147], v[228:231], v[16:19], 0
    s_barrier
    v_xor_b32 v2, 64, v1
    v_mfma_f32_16x16x32_bf16 v[152:155], v[228:231], v[20:23], 0
    ds_read_b128 v[24:27], v2 offset:0
    s_waitcnt lgkmcnt(9)
    v_mfma_f32_16x16x32_bf16 v[132:135], v[232:235], v[16:19], 0
    ds_read_b128 v[28:31], v2 offset:2048
    ds_read_b64_tr_b16 v[224:225], v4 offset:4096
    v_mfma_f32_16x16x32_bf16 v[140:143], v[232:235], v[20:23], 0
    ds_read_b64_tr_b16 v[226:227], v4 offset:4608
    v_mfma_f32_16x16x32_bf16 v[148:151], v[236:239], v[16:19], 0
    ds_read_b64_tr_b16 v[228:229], v4 offset:12288
    ds_read_b64_tr_b16 v[230:231], v4 offset:12800
    v_mfma_f32_16x16x32_bf16 v[156:159], v[236:239], v[20:23], 0
    ds_read_b64_tr_b16 v[232:233], v5 offset:4096
    s_waitcnt lgkmcnt(11)
    v_mfma_f32_16x16x32_bf16 v[160:163], v[240:243], v[16:19], 0
    ds_read_b64_tr_b16 v[234:235], v5 offset:4608
    v_mfma_f32_16x16x32_bf16 v[168:171], v[240:243], v[20:23], 0
    ds_read_b64_tr_b16 v[236:237], v5 offset:12288
    v_mfma_f32_16x16x32_bf16 v[176:179], v[244:247], v[16:19], 0
    ds_read_b64_tr_b16 v[238:239], v5 offset:12800
    v_mfma_f32_16x16x32_bf16 v[184:187], v[244:247], v[20:23], 0
    ds_read_b64_tr_b16 v[240:241], v6 offset:4096
    s_waitcnt lgkmcnt(11)
    v_mfma_f32_16x16x32_bf16 v[164:167], v[248:251], v[16:19], 0
    ds_read_b64_tr_b16 v[242:243], v6 offset:4608
    v_mfma_f32_16x16x32_bf16 v[172:175], v[248:251], v[20:23], 0
    ds_read_b64_tr_b16 v[244:245], v6 offset:12288
    v_mfma_f32_16x16x32_bf16 v[180:183], v[252:255], v[16:19], 0
    ds_read_b64_tr_b16 v[246:247], v6 offset:12800
    v_mfma_f32_16x16x32_bf16 v[188:191], v[252:255], v[20:23], 0
    ds_read_b64_tr_b16 v[248:249], v7 offset:4096
    s_waitcnt lgkmcnt(9)
    v_mfma_f32_16x16x32_bf16 v[128:131], v[224:227], v[24:27], v[128:131]
    ds_read_b64_tr_b16 v[250:251], v7 offset:4608
    v_mfma_f32_16x16x32_bf16 v[136:139], v[224:227], v[28:31], v[136:139]
    ds_read_b64_tr_b16 v[252:253], v7 offset:12288
    v_mfma_f32_16x16x32_bf16 v[144:147], v[228:231], v[24:27], v[144:147]
    ds_read_b64_tr_b16 v[254:255], v7 offset:12800
    v_xor_b32 v2, 32768, v1
    v_mfma_f32_16x16x32_bf16 v[152:155], v[228:231], v[28:31], v[152:155]
    s_barrier
    s_waitcnt lgkmcnt(8)
    v_mfma_f32_16x16x32_bf16 v[132:135], v[232:235], v[24:27], v[132:135]
    ds_read_b128 v[32:35], v2 offset:0
    ds_read_b128 v[36:39], v2 offset:2048
    v_xor_b32 v4, 49152, v3
    v_mfma_f32_16x16x32_bf16 v[140:143], v[232:235], v[28:31], v[140:143]
    ds_read_b64_tr_b16 v[224:225], v4 offset:0
    ds_read_b64_tr_b16 v[226:227], v4 offset:512
    v_mfma_f32_16x16x32_bf16 v[148:151], v[236:239], v[24:27], v[148:151]
    ds_read_b64_tr_b16 v[228:229], v4 offset:8192
    ds_read_b64_tr_b16 v[230:231], v4 offset:8704
    v_xor_b32 v5, 49184, v3
    v_mfma_f32_16x16x32_bf16 v[156:159], v[236:239], v[28:31], v[156:159]
    ds_read_b64_tr_b16 v[232:233], v5 offset:0
    s_waitcnt lgkmcnt(11)
    v_mfma_f32_16x16x32_bf16 v[160:163], v[240:243], v[24:27], v[160:163]
    ds_read_b64_tr_b16 v[234:235], v5 offset:512
    v_mfma_f32_16x16x32_bf16 v[168:171], v[240:243], v[28:31], v[168:171]
    ds_read_b64_tr_b16 v[236:237], v5 offset:8192
    v_mfma_f32_16x16x32_bf16 v[176:179], v[244:247], v[24:27], v[176:179]
    ds_read_b64_tr_b16 v[238:239], v5 offset:8704
    v_xor_b32 v6, 49216, v3
    v_mfma_f32_16x16x32_bf16 v[184:187], v[244:247], v[28:31], v[184:187]
    ds_read_b64_tr_b16 v[240:241], v6 offset:0
    s_waitcnt lgkmcnt(11)
    v_mfma_f32_16x16x32_bf16 v[164:167], v[248:251], v[24:27], v[164:167]
    ds_read_b64_tr_b16 v[242:243], v6 offset:512
    v_mfma_f32_16x16x32_bf16 v[172:175], v[248:251], v[28:31], v[172:175]
    ds_read_b64_tr_b16 v[244:245], v6 offset:8192
    v_mfma_f32_16x16x32_bf16 v[180:183], v[252:255], v[24:27], v[180:183]
    ds_read_b64_tr_b16 v[246:247], v6 offset:8704
    v_xor_b32 v7, 49248, v3
    v_mfma_f32_16x16x32_bf16 v[188:191], v[252:255], v[28:31], v[188:191]
    ds_read_b64_tr_b16 v[248:249], v7 offset:0
    s_waitcnt lgkmcnt(9)
    v_mfma_f32_16x16x32_bf16 v[128:131], v[224:227], v[32:35], v[128:131]
    ds_read_b64_tr_b16 v[250:251], v7 offset:512
    v_mfma_f32_16x16x32_bf16 v[136:139], v[224:227], v[36:39], v[136:139]
    ds_read_b64_tr_b16 v[252:253], v7 offset:8192
    v_mfma_f32_16x16x32_bf16 v[144:147], v[228:231], v[32:35], v[144:147]
    ds_read_b64_tr_b16 v[254:255], v7 offset:8704
    v_xor_b32 v2, 32832, v1
    v_mfma_f32_16x16x32_bf16 v[152:155], v[228:231], v[36:39], v[152:155]
    s_barrier
    s_waitcnt lgkmcnt(8)
    v_mfma_f32_16x16x32_bf16 v[132:135], v[232:235], v[32:35], v[132:135]
    ds_read_b128 v[40:43], v2 offset:0
    ds_read_b128 v[44:47], v2 offset:2048
    v_mfma_f32_16x16x32_bf16 v[140:143], v[232:235], v[36:39], v[140:143]
    ds_read_b64_tr_b16 v[224:225], v4 offset:4096
    ds_read_b64_tr_b16 v[226:227], v4 offset:4608
    v_mfma_f32_16x16x32_bf16 v[148:151], v[236:239], v[32:35], v[148:151]
    ds_read_b64_tr_b16 v[228:229], v4 offset:12288
    ds_read_b64_tr_b16 v[230:231], v4 offset:12800
    v_mfma_f32_16x16x32_bf16 v[156:159], v[236:239], v[36:39], v[156:159]
    ds_read_b64_tr_b16 v[232:233], v5 offset:4096
    s_waitcnt lgkmcnt(11)
    v_mfma_f32_16x16x32_bf16 v[160:163], v[240:243], v[32:35], v[160:163]
    ds_read_b64_tr_b16 v[234:235], v5 offset:4608
    v_mfma_f32_16x16x32_bf16 v[168:171], v[240:243], v[36:39], v[168:171]
    ds_read_b64_tr_b16 v[236:237], v5 offset:12288
    v_mfma_f32_16x16x32_bf16 v[176:179], v[244:247], v[32:35], v[176:179]
    ds_read_b64_tr_b16 v[238:239], v5 offset:12800
    v_mfma_f32_16x16x32_bf16 v[184:187], v[244:247], v[36:39], v[184:187]
    ds_read_b64_tr_b16 v[240:241], v6 offset:4096
    s_waitcnt lgkmcnt(11)
    v_mfma_f32_16x16x32_bf16 v[164:167], v[248:251], v[32:35], v[164:167]
    ds_read_b64_tr_b16 v[242:243], v6 offset:4608
    v_mfma_f32_16x16x32_bf16 v[172:175], v[248:251], v[36:39], v[172:175]
    ds_read_b64_tr_b16 v[244:245], v6 offset:12288
    v_mfma_f32_16x16x32_bf16 v[180:183], v[252:255], v[32:35], v[180:183]
    ds_read_b64_tr_b16 v[246:247], v6 offset:12800
    v_mfma_f32_16x16x32_bf16 v[188:191], v[252:255], v[36:39], v[188:191]
    ds_read_b64_tr_b16 v[248:249], v7 offset:4096
    s_waitcnt lgkmcnt(9)
    v_mfma_f32_16x16x32_bf16 v[128:131], v[224:227], v[40:43], v[128:131]
    ds_read_b64_tr_b16 v[250:251], v7 offset:4608
    v_mfma_f32_16x16x32_bf16 v[136:139], v[224:227], v[44:47], v[136:139]
    ds_read_b64_tr_b16 v[252:253], v7 offset:12288
    v_mfma_f32_16x16x32_bf16 v[144:147], v[228:231], v[40:43], v[144:147]
    ds_read_b64_tr_b16 v[254:255], v7 offset:12800
    v_xor_b32 v2, 65536, v1
    v_mfma_f32_16x16x32_bf16 v[152:155], v[228:231], v[44:47], v[152:155]
    s_barrier
    s_waitcnt lgkmcnt(8)
    v_mfma_f32_16x16x32_bf16 v[132:135], v[232:235], v[40:43], v[132:135]
    ds_read_b128 v[48:51], v2 offset:0
    ds_read_b128 v[52:55], v2 offset:2048
    v_xor_b32 v4, 0, v3
    v_mfma_f32_16x16x32_bf16 v[140:143], v[232:235], v[44:47], v[140:143]
    ds_read_b64_tr_b16 v[224:225], v4 offset:0
    ds_read_b64_tr_b16 v[226:227], v4 offset:512
    v_mfma_f32_16x16x32_bf16 v[148:151], v[236:239], v[40:43], v[148:151]
    ds_read_b64_tr_b16 v[228:229], v4 offset:8192
    ds_read_b64_tr_b16 v[230:231], v4 offset:8704
    v_xor_b32 v5, 32, v3
    v_mfma_f32_16x16x32_bf16 v[156:159], v[236:239], v[44:47], v[156:159]
    ds_read_b64_tr_b16 v[232:233], v5 offset:0
    s_waitcnt lgkmcnt(11)
    v_mfma_f32_16x16x32_bf16 v[160:163], v[240:243], v[40:43], v[160:163]
    ds_read_b64_tr_b16 v[234:235], v5 offset:512
    v_mfma_f32_16x16x32_bf16 v[168:171], v[240:243], v[44:47], v[168:171]
    ds_read_b64_tr_b16 v[236:237], v5 offset:8192
    v_mfma_f32_16x16x32_bf16 v[176:179], v[244:247], v[40:43], v[176:179]
    ds_read_b64_tr_b16 v[238:239], v5 offset:8704
    v_xor_b32 v6, 64, v3
    v_mfma_f32_16x16x32_bf16 v[184:187], v[244:247], v[44:47], v[184:187]
    ds_read_b64_tr_b16 v[240:241], v6 offset:0
    s_waitcnt lgkmcnt(11)
    v_mfma_f32_16x16x32_bf16 v[164:167], v[248:251], v[40:43], v[164:167]
    ds_read_b64_tr_b16 v[242:243], v6 offset:512
    v_mfma_f32_16x16x32_bf16 v[172:175], v[248:251], v[44:47], v[172:175]
    ds_read_b64_tr_b16 v[244:245], v6 offset:8192
    v_mfma_f32_16x16x32_bf16 v[180:183], v[252:255], v[40:43], v[180:183]
    ds_read_b64_tr_b16 v[246:247], v6 offset:8704
    v_xor_b32 v7, 96, v3
    v_mfma_f32_16x16x32_bf16 v[188:191], v[252:255], v[44:47], v[188:191]
    ds_read_b64_tr_b16 v[248:249], v7 offset:0
    s_waitcnt lgkmcnt(9)
    v_mfma_f32_16x16x32_bf16 v[128:131], v[224:227], v[48:51], v[128:131]
    ds_read_b64_tr_b16 v[250:251], v7 offset:512
    v_mfma_f32_16x16x32_bf16 v[136:139], v[224:227], v[52:55], v[136:139]
    ds_read_b64_tr_b16 v[252:253], v7 offset:8192
    v_mfma_f32_16x16x32_bf16 v[144:147], v[228:231], v[48:51], v[144:147]
    ds_read_b64_tr_b16 v[254:255], v7 offset:8704
    v_xor_b32 v2, 65600, v1
    v_mfma_f32_16x16x32_bf16 v[152:155], v[228:231], v[52:55], v[152:155]
    ds_read_b128 v[56:59], v2 offset:0
    s_waitcnt lgkmcnt(9)
    v_mfma_f32_16x16x32_bf16 v[132:135], v[232:235], v[48:51], v[132:135]
    ds_read_b128 v[60:63], v2 offset:2048
    ds_read_b64_tr_b16 v[224:225], v4 offset:4096
    v_mfma_f32_16x16x32_bf16 v[140:143], v[232:235], v[52:55], v[140:143]
    ds_read_b64_tr_b16 v[226:227], v4 offset:4608
    v_mfma_f32_16x16x32_bf16 v[148:151], v[236:239], v[48:51], v[148:151]
    ds_read_b64_tr_b16 v[228:229], v4 offset:12288
    ds_read_b64_tr_b16 v[230:231], v4 offset:12800
    v_mfma_f32_16x16x32_bf16 v[156:159], v[236:239], v[52:55], v[156:159]
    ds_read_b64_tr_b16 v[232:233], v5 offset:4096
    s_waitcnt lgkmcnt(11)
    v_mfma_f32_16x16x32_bf16 v[160:163], v[240:243], v[48:51], v[160:163]
    ds_read_b64_tr_b16 v[234:235], v5 offset:4608
    v_mfma_f32_16x16x32_bf16 v[168:171], v[240:243], v[52:55], v[168:171]
    ds_read_b64_tr_b16 v[236:237], v5 offset:12288
    v_mfma_f32_16x16x32_bf16 v[176:179], v[244:247], v[48:51], v[176:179]
    ds_read_b64_tr_b16 v[238:239], v5 offset:12800
    v_mfma_f32_16x16x32_bf16 v[184:187], v[244:247], v[52:55], v[184:187]
    ds_read_b64_tr_b16 v[240:241], v6 offset:4096
    s_waitcnt lgkmcnt(11)
    v_mfma_f32_16x16x32_bf16 v[164:167], v[248:251], v[48:51], v[164:167]
    ds_read_b64_tr_b16 v[242:243], v6 offset:4608
    v_mfma_f32_16x16x32_bf16 v[172:175], v[248:251], v[52:55], v[172:175]
    ds_read_b64_tr_b16 v[244:245], v6 offset:12288
    v_mfma_f32_16x16x32_bf16 v[180:183], v[252:255], v[48:51], v[180:183]
    ds_read_b64_tr_b16 v[246:247], v6 offset:12800
    v_mfma_f32_16x16x32_bf16 v[188:191], v[252:255], v[52:55], v[188:191]
    ds_read_b64_tr_b16 v[248:249], v7 offset:4096
    s_waitcnt lgkmcnt(9)
    v_mfma_f32_16x16x32_bf16 v[128:131], v[224:227], v[56:59], v[128:131]
    ds_read_b64_tr_b16 v[250:251], v7 offset:4608
    v_mfma_f32_16x16x32_bf16 v[136:139], v[224:227], v[60:63], v[136:139]
    ds_read_b64_tr_b16 v[252:253], v7 offset:12288
    v_mfma_f32_16x16x32_bf16 v[144:147], v[228:231], v[56:59], v[144:147]
    ds_read_b64_tr_b16 v[254:255], v7 offset:12800
    v_xor_b32 v2, 16384, v1
    v_mfma_f32_16x16x32_bf16 v[152:155], v[228:231], v[60:63], v[152:155]
    s_barrier
    s_waitcnt lgkmcnt(8)
    v_mfma_f32_16x16x32_bf16 v[132:135], v[232:235], v[56:59], v[132:135]
    ds_read_b128 v[64:67], v2 offset:0
    ds_read_b128 v[68:71], v2 offset:2048
    v_xor_b32 v4, 81920, v3
    v_mfma_f32_16x16x32_bf16 v[140:143], v[232:235], v[60:63], v[140:143]
    ds_read_b64_tr_b16 v[224:225], v4 offset:0
    ds_read_b64_tr_b16 v[226:227], v4 offset:512
    v_mfma_f32_16x16x32_bf16 v[148:151], v[236:239], v[56:59], v[148:151]
    ds_read_b64_tr_b16 v[228:229], v4 offset:8192
    ds_read_b64_tr_b16 v[230:231], v4 offset:8704
    v_xor_b32 v5, 81952, v3
    v_mfma_f32_16x16x32_bf16 v[156:159], v[236:239], v[60:63], v[156:159]
    ds_read_b64_tr_b16 v[232:233], v5 offset:0
    s_waitcnt lgkmcnt(11)
    v_mfma_f32_16x16x32_bf16 v[160:163], v[240:243], v[56:59], v[160:163]
    ds_read_b64_tr_b16 v[234:235], v5 offset:512
    v_mfma_f32_16x16x32_bf16 v[168:171], v[240:243], v[60:63], v[168:171]
    ds_read_b64_tr_b16 v[236:237], v5 offset:8192
    v_mfma_f32_16x16x32_bf16 v[176:179], v[244:247], v[56:59], v[176:179]
    ds_read_b64_tr_b16 v[238:239], v5 offset:8704
    v_xor_b32 v6, 81984, v3
    v_mfma_f32_16x16x32_bf16 v[184:187], v[244:247], v[60:63], v[184:187]
    ds_read_b64_tr_b16 v[240:241], v6 offset:0
    s_waitcnt lgkmcnt(11)
    v_mfma_f32_16x16x32_bf16 v[164:167], v[248:251], v[56:59], v[164:167]
    ds_read_b64_tr_b16 v[242:243], v6 offset:512
    v_mfma_f32_16x16x32_bf16 v[172:175], v[248:251], v[60:63], v[172:175]
    ds_read_b64_tr_b16 v[244:245], v6 offset:8192
    v_mfma_f32_16x16x32_bf16 v[180:183], v[252:255], v[56:59], v[180:183]
    ds_read_b64_tr_b16 v[246:247], v6 offset:8704
    v_xor_b32 v7, 82016, v3
    v_mfma_f32_16x16x32_bf16 v[188:191], v[252:255], v[60:63], v[188:191]
    ds_read_b64_tr_b16 v[248:249], v7 offset:0
    s_waitcnt lgkmcnt(9)
    v_mfma_f32_16x16x32_bf16 v[128:131], v[224:227], v[64:67], v[128:131]
    ds_read_b64_tr_b16 v[250:251], v7 offset:512
    v_mfma_f32_16x16x32_bf16 v[136:139], v[224:227], v[68:71], v[136:139]
    ds_read_b64_tr_b16 v[252:253], v7 offset:8192
    v_mfma_f32_16x16x32_bf16 v[144:147], v[228:231], v[64:67], v[144:147]
    ds_read_b64_tr_b16 v[254:255], v7 offset:8704
    v_xor_b32 v2, 16448, v1
    v_mfma_f32_16x16x32_bf16 v[152:155], v[228:231], v[68:71], v[152:155]
    ds_read_b128 v[72:75], v2 offset:0
    s_waitcnt lgkmcnt(9)
    v_mfma_f32_16x16x32_bf16 v[132:135], v[232:235], v[64:67], v[132:135]
    ds_read_b128 v[76:79], v2 offset:2048
    ds_read_b64_tr_b16 v[224:225], v4 offset:4096
    v_mfma_f32_16x16x32_bf16 v[140:143], v[232:235], v[68:71], v[140:143]
    ds_read_b64_tr_b16 v[226:227], v4 offset:4608
    v_mfma_f32_16x16x32_bf16 v[148:151], v[236:239], v[64:67], v[148:151]
    ds_read_b64_tr_b16 v[228:229], v4 offset:12288
    ds_read_b64_tr_b16 v[230:231], v4 offset:12800
    v_mfma_f32_16x16x32_bf16 v[156:159], v[236:239], v[68:71], v[156:159]
    ds_read_b64_tr_b16 v[232:233], v5 offset:4096
    s_waitcnt lgkmcnt(11)
    v_mfma_f32_16x16x32_bf16 v[160:163], v[240:243], v[64:67], v[160:163]
    ds_read_b64_tr_b16 v[234:235], v5 offset:4608
    v_mfma_f32_16x16x32_bf16 v[168:171], v[240:243], v[68:71], v[168:171]
    ds_read_b64_tr_b16 v[236:237], v5 offset:12288
    v_mfma_f32_16x16x32_bf16 v[176:179], v[244:247], v[64:67], v[176:179]
    ds_read_b64_tr_b16 v[238:239], v5 offset:12800
    v_mfma_f32_16x16x32_bf16 v[184:187], v[244:247], v[68:71], v[184:187]
    ds_read_b64_tr_b16 v[240:241], v6 offset:4096
    s_waitcnt lgkmcnt(11)
    v_mfma_f32_16x16x32_bf16 v[164:167], v[248:251], v[64:67], v[164:167]
    ds_read_b64_tr_b16 v[242:243], v6 offset:4608
    v_mfma_f32_16x16x32_bf16 v[172:175], v[248:251], v[68:71], v[172:175]
    ds_read_b64_tr_b16 v[244:245], v6 offset:12288
    v_mfma_f32_16x16x32_bf16 v[180:183], v[252:255], v[64:67], v[180:183]
    ds_read_b64_tr_b16 v[246:247], v6 offset:12800
    v_mfma_f32_16x16x32_bf16 v[188:191], v[252:255], v[68:71], v[188:191]
    ds_read_b64_tr_b16 v[248:249], v7 offset:4096
    s_waitcnt lgkmcnt(9)
    v_mfma_f32_16x16x32_bf16 v[128:131], v[224:227], v[72:75], v[128:131]
    ds_read_b64_tr_b16 v[250:251], v7 offset:4608
    v_mfma_f32_16x16x32_bf16 v[136:139], v[224:227], v[76:79], v[136:139]
    ds_read_b64_tr_b16 v[252:253], v7 offset:12288
    v_mfma_f32_16x16x32_bf16 v[144:147], v[228:231], v[72:75], v[144:147]
    ds_read_b64_tr_b16 v[254:255], v7 offset:12800
    v_xor_b32 v2, 32768, v1
    v_mfma_f32_16x16x32_bf16 v[152:155], v[228:231], v[76:79], v[152:155]
    s_barrier
    s_waitcnt lgkmcnt(8)
    v_mfma_f32_16x16x32_bf16 v[132:135], v[232:235], v[72:75], v[132:135]
    ds_read_b128 v[80:83], v2 offset:0
    ds_read_b128 v[84:87], v2 offset:2048
    v_xor_b32 v4, 98304, v3
    v_mfma_f32_16x16x32_bf16 v[140:143], v[232:235], v[76:79], v[140:143]
    ds_read_b64_tr_b16 v[224:225], v4 offset:0
    ds_read_b64_tr_b16 v[226:227], v4 offset:512
    v_mfma_f32_16x16x32_bf16 v[148:151], v[236:239], v[72:75], v[148:151]
    ds_read_b64_tr_b16 v[228:229], v4 offset:8192
    ds_read_b64_tr_b16 v[230:231], v4 offset:8704
    v_xor_b32 v5, 98336, v3
    v_mfma_f32_16x16x32_bf16 v[156:159], v[236:239], v[76:79], v[156:159]
    ds_read_b64_tr_b16 v[232:233], v5 offset:0
    s_waitcnt lgkmcnt(11)
    v_mfma_f32_16x16x32_bf16 v[160:163], v[240:243], v[72:75], v[160:163]
    ds_read_b64_tr_b16 v[234:235], v5 offset:512
    v_mfma_f32_16x16x32_bf16 v[168:171], v[240:243], v[76:79], v[168:171]
    ds_read_b64_tr_b16 v[236:237], v5 offset:8192
    v_mfma_f32_16x16x32_bf16 v[176:179], v[244:247], v[72:75], v[176:179]
    ds_read_b64_tr_b16 v[238:239], v5 offset:8704
    v_xor_b32 v6, 98368, v3
    v_mfma_f32_16x16x32_bf16 v[184:187], v[244:247], v[76:79], v[184:187]
    ds_read_b64_tr_b16 v[240:241], v6 offset:0
    s_waitcnt lgkmcnt(11)
    v_mfma_f32_16x16x32_bf16 v[164:167], v[248:251], v[72:75], v[164:167]
    ds_read_b64_tr_b16 v[242:243], v6 offset:512
    v_mfma_f32_16x16x32_bf16 v[172:175], v[248:251], v[76:79], v[172:175]
    ds_read_b64_tr_b16 v[244:245], v6 offset:8192
    v_mfma_f32_16x16x32_bf16 v[180:183], v[252:255], v[72:75], v[180:183]
    ds_read_b64_tr_b16 v[246:247], v6 offset:8704
    v_xor_b32 v7, 98400, v3
    v_mfma_f32_16x16x32_bf16 v[188:191], v[252:255], v[76:79], v[188:191]
    ds_read_b64_tr_b16 v[248:249], v7 offset:0
    s_waitcnt lgkmcnt(9)
    v_mfma_f32_16x16x32_bf16 v[128:131], v[224:227], v[80:83], v[128:131]
    ds_read_b64_tr_b16 v[250:251], v7 offset:512
    v_mfma_f32_16x16x32_bf16 v[136:139], v[224:227], v[84:87], v[136:139]
    ds_read_b64_tr_b16 v[252:253], v7 offset:8192
    v_mfma_f32_16x16x32_bf16 v[144:147], v[228:231], v[80:83], v[144:147]
    ds_read_b64_tr_b16 v[254:255], v7 offset:8704
    v_xor_b32 v2, 32832, v1
    v_mfma_f32_16x16x32_bf16 v[152:155], v[228:231], v[84:87], v[152:155]
    ds_read_b128 v[88:91], v2 offset:0
    s_waitcnt lgkmcnt(9)
    v_mfma_f32_16x16x32_bf16 v[132:135], v[232:235], v[80:83], v[132:135]
    ds_read_b128 v[92:95], v2 offset:2048
    ds_read_b64_tr_b16 v[224:225], v4 offset:4096
    v_mfma_f32_16x16x32_bf16 v[140:143], v[232:235], v[84:87], v[140:143]
    ds_read_b64_tr_b16 v[226:227], v4 offset:4608
    v_mfma_f32_16x16x32_bf16 v[148:151], v[236:239], v[80:83], v[148:151]
    ds_read_b64_tr_b16 v[228:229], v4 offset:12288
    ds_read_b64_tr_b16 v[230:231], v4 offset:12800
    v_mfma_f32_16x16x32_bf16 v[156:159], v[236:239], v[84:87], v[156:159]
    ds_read_b64_tr_b16 v[232:233], v5 offset:4096
    s_waitcnt lgkmcnt(11)
    v_mfma_f32_16x16x32_bf16 v[160:163], v[240:243], v[80:83], v[160:163]
    ds_read_b64_tr_b16 v[234:235], v5 offset:4608
    v_mfma_f32_16x16x32_bf16 v[168:171], v[240:243], v[84:87], v[168:171]
    ds_read_b64_tr_b16 v[236:237], v5 offset:12288
    v_mfma_f32_16x16x32_bf16 v[176:179], v[244:247], v[80:83], v[176:179]
    ds_read_b64_tr_b16 v[238:239], v5 offset:12800
    v_mfma_f32_16x16x32_bf16 v[184:187], v[244:247], v[84:87], v[184:187]
    ds_read_b64_tr_b16 v[240:241], v6 offset:4096
    s_waitcnt lgkmcnt(11)
    v_mfma_f32_16x16x32_bf16 v[164:167], v[248:251], v[80:83], v[164:167]
    ds_read_b64_tr_b16 v[242:243], v6 offset:4608
    v_mfma_f32_16x16x32_bf16 v[172:175], v[248:251], v[84:87], v[172:175]
    ds_read_b64_tr_b16 v[244:245], v6 offset:12288
    v_mfma_f32_16x16x32_bf16 v[180:183], v[252:255], v[80:83], v[180:183]
    ds_read_b64_tr_b16 v[246:247], v6 offset:12800
    v_mfma_f32_16x16x32_bf16 v[188:191], v[252:255], v[84:87], v[188:191]
    ds_read_b64_tr_b16 v[248:249], v7 offset:4096
    s_waitcnt lgkmcnt(9)
    v_mfma_f32_16x16x32_bf16 v[128:131], v[224:227], v[88:91], v[128:131]
    ds_read_b64_tr_b16 v[250:251], v7 offset:4608
    v_mfma_f32_16x16x32_bf16 v[136:139], v[224:227], v[92:95], v[136:139]
    ds_read_b64_tr_b16 v[252:253], v7 offset:12288
    v_mfma_f32_16x16x32_bf16 v[144:147], v[228:231], v[88:91], v[144:147]
    ds_read_b64_tr_b16 v[254:255], v7 offset:12800
    v_xor_b32 v2, 114688, v1
    v_mfma_f32_16x16x32_bf16 v[152:155], v[228:231], v[92:95], v[152:155]
    s_barrier
    s_waitcnt lgkmcnt(8)
    v_mfma_f32_16x16x32_bf16 v[132:135], v[232:235], v[88:91], v[132:135]
    ds_read_b128 v[96:99], v2 offset:0
    ds_read_b128 v[100:103], v2 offset:2048
    v_xor_b32 v4, 131072, v3
    v_mfma_f32_16x16x32_bf16 v[140:143], v[232:235], v[92:95], v[140:143]
    ds_read_b64_tr_b16 v[224:225], v4 offset:0
    ds_read_b64_tr_b16 v[226:227], v4 offset:512
    v_mfma_f32_16x16x32_bf16 v[148:151], v[236:239], v[88:91], v[148:151]
    ds_read_b64_tr_b16 v[228:229], v4 offset:8192
    ds_read_b64_tr_b16 v[230:231], v4 offset:8704
    v_xor_b32 v5, 131104, v3
    v_mfma_f32_16x16x32_bf16 v[156:159], v[236:239], v[92:95], v[156:159]
    ds_read_b64_tr_b16 v[232:233], v5 offset:0
    s_waitcnt lgkmcnt(11)
    v_mfma_f32_16x16x32_bf16 v[160:163], v[240:243], v[88:91], v[160:163]
    ds_read_b64_tr_b16 v[234:235], v5 offset:512
    v_mfma_f32_16x16x32_bf16 v[168:171], v[240:243], v[92:95], v[168:171]
    ds_read_b64_tr_b16 v[236:237], v5 offset:8192
    s_load_dwordx2 s[74:75], s[36:37], 0
    v_mfma_f32_16x16x32_bf16 v[176:179], v[244:247], v[88:91], v[176:179]
    ds_read_b64_tr_b16 v[238:239], v5 offset:8704
    v_xor_b32 v6, 131136, v3
    v_mfma_f32_16x16x32_bf16 v[184:187], v[244:247], v[92:95], v[184:187]
    ds_read_b64_tr_b16 v[240:241], v6 offset:0
    s_waitcnt lgkmcnt(11)
    v_mfma_f32_16x16x32_bf16 v[164:167], v[248:251], v[88:91], v[164:167]
    ds_read_b64_tr_b16 v[242:243], v6 offset:512
    v_mfma_f32_16x16x32_bf16 v[172:175], v[248:251], v[92:95], v[172:175]
    ds_read_b64_tr_b16 v[244:245], v6 offset:8192
    v_mfma_f32_16x16x32_bf16 v[180:183], v[252:255], v[88:91], v[180:183]
    ds_read_b64_tr_b16 v[246:247], v6 offset:8704
    v_xor_b32 v7, 131168, v3
    v_mfma_f32_16x16x32_bf16 v[188:191], v[252:255], v[92:95], v[188:191]
    ds_read_b64_tr_b16 v[248:249], v7 offset:0
    s_waitcnt lgkmcnt(9)
    v_mfma_f32_16x16x32_bf16 v[128:131], v[224:227], v[96:99], v[128:131]
    ds_read_b64_tr_b16 v[250:251], v7 offset:512
    v_mfma_f32_16x16x32_bf16 v[136:139], v[224:227], v[100:103], v[136:139]
    ds_read_b64_tr_b16 v[252:253], v7 offset:8192
    v_mfma_f32_16x16x32_bf16 v[144:147], v[228:231], v[96:99], v[144:147]
    ds_read_b64_tr_b16 v[254:255], v7 offset:8704
    v_xor_b32 v2, 114752, v1
    v_mfma_f32_16x16x32_bf16 v[152:155], v[228:231], v[100:103], v[152:155]
    ds_read_b128 v[104:107], v2 offset:0
    s_waitcnt lgkmcnt(9)
    v_mfma_f32_16x16x32_bf16 v[132:135], v[232:235], v[96:99], v[132:135]
    ds_read_b128 v[108:111], v2 offset:2048
    ds_read_b64_tr_b16 v[224:225], v4 offset:4096
    v_mfma_f32_16x16x32_bf16 v[140:143], v[232:235], v[100:103], v[140:143]
    ds_read_b64_tr_b16 v[226:227], v4 offset:4608
    v_mfma_f32_16x16x32_bf16 v[148:151], v[236:239], v[96:99], v[148:151]
    ds_read_b64_tr_b16 v[228:229], v4 offset:12288
    ds_read_b64_tr_b16 v[230:231], v4 offset:12800
    v_mfma_f32_16x16x32_bf16 v[156:159], v[236:239], v[100:103], v[156:159]
    ds_read_b64_tr_b16 v[232:233], v5 offset:4096
    s_waitcnt lgkmcnt(11)
    v_mfma_f32_16x16x32_bf16 v[160:163], v[240:243], v[96:99], v[160:163]
    ds_read_b64_tr_b16 v[234:235], v5 offset:4608
    v_mfma_f32_16x16x32_bf16 v[168:171], v[240:243], v[100:103], v[168:171]
    ds_read_b64_tr_b16 v[236:237], v5 offset:12288
    v_mfma_f32_16x16x32_bf16 v[176:179], v[244:247], v[96:99], v[176:179]
    ds_read_b64_tr_b16 v[238:239], v5 offset:12800
    v_mfma_f32_16x16x32_bf16 v[184:187], v[244:247], v[100:103], v[184:187]
    ds_read_b64_tr_b16 v[240:241], v6 offset:4096
    s_waitcnt lgkmcnt(11)
    v_mfma_f32_16x16x32_bf16 v[164:167], v[248:251], v[96:99], v[164:167]
    ds_read_b64_tr_b16 v[242:243], v6 offset:4608
    v_mfma_f32_16x16x32_bf16 v[172:175], v[248:251], v[100:103], v[172:175]
    ds_read_b64_tr_b16 v[244:245], v6 offset:12288
    v_mfma_f32_16x16x32_bf16 v[180:183], v[252:255], v[96:99], v[180:183]
    ds_read_b64_tr_b16 v[246:247], v6 offset:12800
    v_mfma_f32_16x16x32_bf16 v[188:191], v[252:255], v[100:103], v[188:191]
    ds_read_b64_tr_b16 v[248:249], v7 offset:4096
    s_waitcnt lgkmcnt(9)
    v_mfma_f32_16x16x32_bf16 v[128:131], v[224:227], v[104:107], v[128:131]
    ds_read_b64_tr_b16 v[250:251], v7 offset:4608
    v_mfma_f32_16x16x32_bf16 v[136:139], v[224:227], v[108:111], v[136:139]
    ds_read_b64_tr_b16 v[252:253], v7 offset:12288
    v_mfma_f32_16x16x32_bf16 v[144:147], v[228:231], v[104:107], v[144:147]
    ds_read_b64_tr_b16 v[254:255], v7 offset:12800
    v_xor_b32 v2, 49152, v1
    v_mfma_f32_16x16x32_bf16 v[152:155], v[228:231], v[108:111], v[152:155]
    s_barrier
    s_waitcnt lgkmcnt(8)
    v_mfma_f32_16x16x32_bf16 v[132:135], v[232:235], v[104:107], v[132:135]
    ds_read_b128 v[112:115], v2 offset:0
    ds_read_b128 v[116:119], v2 offset:2048
    v_xor_b32 v4, 65536, v3
    v_mfma_f32_16x16x32_bf16 v[140:143], v[232:235], v[108:111], v[140:143]
    ds_read_b64_tr_b16 v[224:225], v4 offset:0
    ds_read_b64_tr_b16 v[226:227], v4 offset:512
    v_mfma_f32_16x16x32_bf16 v[148:151], v[236:239], v[104:107], v[148:151]
    ds_read_b64_tr_b16 v[228:229], v4 offset:8192
    ds_read_b64_tr_b16 v[230:231], v4 offset:8704
    v_xor_b32 v5, 65568, v3
    v_mfma_f32_16x16x32_bf16 v[156:159], v[236:239], v[108:111], v[156:159]
    ds_read_b64_tr_b16 v[232:233], v5 offset:0
    s_waitcnt lgkmcnt(11)
    v_mfma_f32_16x16x32_bf16 v[160:163], v[240:243], v[104:107], v[160:163]
    ds_read_b64_tr_b16 v[234:235], v5 offset:512
    v_mfma_f32_16x16x32_bf16 v[168:171], v[240:243], v[108:111], v[168:171]
    ds_read_b64_tr_b16 v[236:237], v5 offset:8192
    v_mfma_f32_16x16x32_bf16 v[176:179], v[244:247], v[104:107], v[176:179]
    ds_read_b64_tr_b16 v[238:239], v5 offset:8704
    v_xor_b32 v2, 49216, v1
    v_mfma_f32_16x16x32_bf16 v[184:187], v[244:247], v[108:111], v[184:187]
    ds_read_b128 v[120:123], v2 offset:0
    s_waitcnt lgkmcnt(11)
    v_mfma_f32_16x16x32_bf16 v[164:167], v[248:251], v[104:107], v[164:167]
    ds_read_b128 v[124:127], v2 offset:2048
    ds_read_b64_tr_b16 v[240:241], v4 offset:4096
    v_mfma_f32_16x16x32_bf16 v[172:175], v[248:251], v[108:111], v[172:175]
    ds_read_b64_tr_b16 v[242:243], v4 offset:4608
    v_mfma_f32_16x16x32_bf16 v[180:183], v[252:255], v[104:107], v[180:183]
    ds_read_b64_tr_b16 v[244:245], v4 offset:12288
    s_waitcnt lgkmcnt(14)
    ds_read_b64_tr_b16 v[246:247], v4 offset:12800
    v_mfma_f32_16x16x32_bf16 v[188:191], v[252:255], v[108:111], v[188:191]
    s_waitcnt lgkmcnt(14)
    ds_read_b64_tr_b16 v[248:249], v5 offset:4096
    s_waitcnt lgkmcnt(11)
    v_mfma_f32_16x16x32_bf16 v[128:131], v[224:227], v[112:115], v[128:131]
    ds_read_b64_tr_b16 v[250:251], v5 offset:4608
    v_mfma_f32_16x16x32_bf16 v[136:139], v[224:227], v[116:119], v[136:139]
    ds_read_b64_tr_b16 v[252:253], v5 offset:12288
    v_mfma_f32_16x16x32_bf16 v[144:147], v[228:231], v[112:115], v[144:147]
    ds_read_b64_tr_b16 v[254:255], v5 offset:12800
    v_xor_b32 v6, 65600, v3
    v_mfma_f32_16x16x32_bf16 v[152:155], v[228:231], v[116:119], v[152:155]
    ds_read_b64_tr_b16 v[224:225], v6 offset:0
    s_waitcnt lgkmcnt(11)
    v_mfma_f32_16x16x32_bf16 v[132:135], v[232:235], v[112:115], v[132:135]
    ds_read_b64_tr_b16 v[226:227], v6 offset:512
    v_mfma_f32_16x16x32_bf16 v[140:143], v[232:235], v[116:119], v[140:143]
    ds_read_b64_tr_b16 v[228:229], v6 offset:8192
    v_mfma_f32_16x16x32_bf16 v[148:151], v[236:239], v[112:115], v[148:151]
    ds_read_b64_tr_b16 v[230:231], v6 offset:8704
    v_xor_b32 v7, 65632, v3
    v_mfma_f32_16x16x32_bf16 v[156:159], v[236:239], v[116:119], v[156:159]
    ds_read_b64_tr_b16 v[232:233], v7 offset:0
    s_waitcnt lgkmcnt(9)
    v_mfma_f32_16x16x32_bf16 v[128:131], v[240:243], v[120:123], v[128:131]
    ds_read_b64_tr_b16 v[234:235], v7 offset:512
    v_mfma_f32_16x16x32_bf16 v[136:139], v[240:243], v[124:127], v[136:139]
    ds_read_b64_tr_b16 v[236:237], v7 offset:8192
    v_mfma_f32_16x16x32_bf16 v[144:147], v[244:247], v[120:123], v[144:147]
    ds_read_b64_tr_b16 v[238:239], v7 offset:8704
    v_mfma_f32_16x16x32_bf16 v[152:155], v[244:247], v[124:127], v[152:155]
    ds_read_b64_tr_b16 v[240:241], v6 offset:4096
    s_waitcnt lgkmcnt(0)
    s_cmp_lg_u32 s75, 0
    s_cbranch_scc0 L_slC0
L_ckC0:
    v_mov_b32 v12, s74
    v_mov_b32 v13, s75
    v_mfma_f32_16x16x32_bf16 v[132:135], v[248:251], v[120:123], v[132:135]
    ds_read_b64_tr_b16 v[242:243], v6 offset:4608
    v_mfma_f32_16x16x32_bf16 v[140:143], v[248:251], v[124:127], v[140:143]
    ds_read_b64_tr_b16 v[244:245], v6 offset:12288
    v_mfma_f32_16x16x32_bf16 v[148:151], v[252:255], v[120:123], v[148:151]
    ds_read_b64_tr_b16 v[246:247], v6 offset:12800
    v_mfma_f32_16x16x32_bf16 v[156:159], v[252:255], v[124:127], v[156:159]
    ds_read_b64_tr_b16 v[248:249], v7 offset:4096
    v_mfma_f32_16x16x32_bf16 v[160:163], v[224:227], v[112:115], v[160:163]
    ds_read_b64_tr_b16 v[250:251], v7 offset:4608
    v_mfma_f32_16x16x32_bf16 v[168:171], v[224:227], v[116:119], v[168:171]
    ds_read_b64_tr_b16 v[252:253], v7 offset:12288
    v_mfma_f32_16x16x32_bf16 v[176:179], v[228:231], v[112:115], v[176:179]
    ds_read_b64_tr_b16 v[254:255], v7 offset:12800
    v_xor_b32 v4, 0, v3
    v_mfma_f32_16x16x32_bf16 v[184:187], v[228:231], v[116:119], v[184:187]
    s_barrier
    v_mfma_f32_16x16x32_bf16 v[164:167], v[232:235], v[112:115], v[164:167]
    ds_read_b64_tr_b16 v[224:225], v4 offset:0
    ds_read_b64_tr_b16 v[226:227], v4 offset:512
    v_mfma_f32_16x16x32_bf16 v[172:175], v[232:235], v[116:119], v[172:175]
    v_mul_f32 v128, s59, v128
    v_mul_f32 v129, s59, v129
    v_mul_f32 v130, s59, v130
    v_mul_f32 v131, s59, v131
    v_mfma_f32_16x16x32_bf16 v[180:183], v[236:239], v[112:115], v[180:183]
    ds_read_b64_tr_b16 v[228:229], v4 offset:8192
    ds_read_b64_tr_b16 v[230:231], v4 offset:8704
    v_xor_b32 v5, 32, v3
    v_mfma_f32_16x16x32_bf16 v[188:191], v[236:239], v[116:119], v[188:191]
    v_exp_f32 v128, v128
    v_exp_f32 v129, v129
    s_waitcnt lgkmcnt(8)
    v_mfma_f32_16x16x32_bf16 v[160:163], v[240:243], v[120:123], v[160:163]
    ds_read_b64_tr_b16 v[232:233], v5 offset:0
    ds_read_b64_tr_b16 v[234:235], v5 offset:512
    v_mfma_f32_16x16x32_bf16 v[168:171], v[240:243], v[124:127], v[168:171]
    v_exp_f32 v130, v130
    v_exp_f32 v131, v131
    v_add_f32 v128, 1.0, v128
    v_add_f32 v129, 1.0, v129
    v_mfma_f32_16x16x32_bf16 v[176:179], v[244:247], v[120:123], v[176:179]
    ds_read_b64_tr_b16 v[236:237], v5 offset:8192
    ds_read_b64_tr_b16 v[238:239], v5 offset:8704
    v_mfma_f32_16x16x32_bf16 v[184:187], v[244:247], v[124:127], v[184:187]
    v_add_f32 v130, 1.0, v130
    v_add_f32 v131, 1.0, v131
    v_rcp_f32 v128, v128
    s_waitcnt lgkmcnt(8)
    v_mfma_f32_16x16x32_bf16 v[164:167], v[248:251], v[120:123], v[164:167]
    ds_read_b64_tr_b16 v[240:241], v4 offset:4096
    ds_read_b64_tr_b16 v[242:243], v4 offset:4608
    v_mfma_f32_16x16x32_bf16 v[172:175], v[248:251], v[124:127], v[172:175]
    v_rcp_f32 v129, v129
    v_rcp_f32 v130, v130
    v_mfma_f32_16x16x32_bf16 v[180:183], v[252:255], v[120:123], v[180:183]
    ds_read_b64_tr_b16 v[244:245], v4 offset:12288
    ds_read_b64_tr_b16 v[246:247], v4 offset:12800
    v_mfma_f32_16x16x32_bf16 v[188:191], v[252:255], v[124:127], v[188:191]
    v_rcp_f32 v131, v131
    v_mul_f32 v128, v128, v144
    v_mul_f32 v129, v129, v145
    v_mul_f32 v130, v130, v146
    s_waitcnt lgkmcnt(8)
    v_mfma_f32_16x16x32_bf16 v[192:195], v[224:227], v[16:19], 0
    ds_read_b64_tr_b16 v[248:249], v5 offset:4096
    ds_read_b64_tr_b16 v[250:251], v5 offset:4608
    v_mfma_f32_16x16x32_bf16 v[200:203], v[224:227], v[20:23], 0
    v_mul_f32 v131, v131, v147
    v_cvt_pk_bf16_f32 v144, v128, v129
    v_cvt_pk_bf16_f32 v145, v130, v131
    v_mul_f32 v132, s59, v132
    v_mul_f32 v133, s59, v133
    v_mfma_f32_16x16x32_bf16 v[208:211], v[228:231], v[16:19], 0
    ds_read_b64_tr_b16 v[252:253], v5 offset:12288
    ds_read_b64_tr_b16 v[254:255], v5 offset:12800
    v_xor_b32 v4, 16384, v3
    v_mfma_f32_16x16x32_bf16 v[216:219], v[228:231], v[20:23], 0
    v_mul_f32 v134, s59, v134
    v_mul_f32 v135, s59, v135
    v_exp_f32 v132, v132
    s_waitcnt lgkmcnt(8)
    v_mfma_f32_16x16x32_bf16 v[196:199], v[232:235], v[16:19], 0
    ds_read_b64_tr_b16 v[224:225], v4 offset:0
    ds_read_b64_tr_b16 v[226:227], v4 offset:512
    v_mfma_f32_16x16x32_bf16 v[204:207], v[232:235], v[20:23], 0
    v_exp_f32 v133, v133
    v_exp_f32 v134, v134
    v_mfma_f32_16x16x32_bf16 v[212:215], v[236:239], v[16:19], 0
    ds_read_b64_tr_b16 v[228:229], v4 offset:8192
    ds_read_b64_tr_b16 v[230:231], v4 offset:8704
    v_xor_b32 v5, 16416, v3
    v_mfma_f32_16x16x32_bf16 v[220:223], v[236:239], v[20:23], 0
    v_exp_f32 v135, v135
    v_add_f32 v132, 1.0, v132
    v_add_f32 v133, 1.0, v133
    v_add_f32 v134, 1.0, v134
    s_waitcnt lgkmcnt(8)
    v_mfma_f32_16x16x32_bf16 v[192:195], v[240:243], v[24:27], v[192:195]
    ds_read_b64_tr_b16 v[232:233], v5 offset:0
    ds_read_b64_tr_b16 v[234:235], v5 offset:512
    v_mfma_f32_16x16x32_bf16 v[200:203], v[240:243], v[28:31], v[200:203]
    v_add_f32 v135, 1.0, v135
    v_rcp_f32 v132, v132
    v_rcp_f32 v133, v133
    v_mfma_f32_16x16x32_bf16 v[208:211], v[244:247], v[24:27], v[208:211]
    ds_read_b64_tr_b16 v[236:237], v5 offset:8192
    ds_read_b64_tr_b16 v[238:239], v5 offset:8704
    v_mfma_f32_16x16x32_bf16 v[216:219], v[244:247], v[28:31], v[216:219]
    v_rcp_f32 v134, v134
    v_rcp_f32 v135, v135
    s_waitcnt lgkmcnt(8)
    v_mfma_f32_16x16x32_bf16 v[196:199], v[248:251], v[24:27], v[196:199]
    ds_read_b64_tr_b16 v[240:241], v4 offset:4096
    ds_read_b64_tr_b16 v[242:243], v4 offset:4608
    v_mfma_f32_16x16x32_bf16 v[204:207], v[248:251], v[28:31], v[204:207]
    v_mul_f32 v132, v132, v148
    v_mul_f32 v133, v133, v149
    v_mul_f32 v134, v134, v150
    v_mul_f32 v135, v135, v151
    v_cvt_pk_bf16_f32 v146, v132, v133
    v_mfma_f32_16x16x32_bf16 v[212:215], v[252:255], v[24:27], v[212:215]
    ds_read_b64_tr_b16 v[244:245], v4 offset:12288
    ds_read_b64_tr_b16 v[246:247], v4 offset:12800
    v_mfma_f32_16x16x32_bf16 v[220:223], v[252:255], v[28:31], v[220:223]
    v_cvt_pk_bf16_f32 v147, v134, v135
    buffer_store_dwordx4 v[144:147], v9, s[32:35], s54 offen offset:0 sc1
    s_waitcnt lgkmcnt(8)
    v_mfma_f32_16x16x32_bf16 v[192:195], v[224:227], v[32:35], v[192:195]
    ds_read_b64_tr_b16 v[248:249], v5 offset:4096
    ds_read_b64_tr_b16 v[250:251], v5 offset:4608
    v_mfma_f32_16x16x32_bf16 v[200:203], v[224:227], v[36:39], v[200:203]
    v_mul_f32 v136, s59, v136
    v_mul_f32 v137, s59, v137
    v_mul_f32 v138, s59, v138
    v_mul_f32 v139, s59, v139
    v_mfma_f32_16x16x32_bf16 v[208:211], v[228:231], v[32:35], v[208:211]
    ds_read_b64_tr_b16 v[252:253], v5 offset:12288
    ds_read_b64_tr_b16 v[254:255], v5 offset:12800
    v_mfma_f32_16x16x32_bf16 v[216:219], v[228:231], v[36:39], v[216:219]
    s_barrier
    v_xor_b32 v4, 32768, v3
    v_exp_f32 v136, v136
    v_exp_f32 v137, v137
    s_waitcnt lgkmcnt(8)
    v_mfma_f32_16x16x32_bf16 v[196:199], v[232:235], v[32:35], v[196:199]
    ds_read_b64_tr_b16 v[224:225], v4 offset:0
    ds_read_b64_tr_b16 v[226:227], v4 offset:512
    v_mfma_f32_16x16x32_bf16 v[204:207], v[232:235], v[36:39], v[204:207]
    v_exp_f32 v138, v138
    v_exp_f32 v139, v139
    v_add_f32 v136, 1.0, v136
    v_add_f32 v137, 1.0, v137
    v_mfma_f32_16x16x32_bf16 v[212:215], v[236:239], v[32:35], v[212:215]
    ds_read_b64_tr_b16 v[228:229], v4 offset:8192
    ds_read_b64_tr_b16 v[230:231], v4 offset:8704
    v_xor_b32 v5, 32800, v3
    v_mfma_f32_16x16x32_bf16 v[220:223], v[236:239], v[36:39], v[220:223]
    v_add_f32 v138, 1.0, v138
    v_add_f32 v139, 1.0, v139
    v_rcp_f32 v136, v136
    s_waitcnt lgkmcnt(8)
    v_mfma_f32_16x16x32_bf16 v[192:195], v[240:243], v[40:43], v[192:195]
    ds_read_b64_tr_b16 v[232:233], v5 offset:0
    ds_read_b64_tr_b16 v[234:235], v5 offset:512
    v_mfma_f32_16x16x32_bf16 v[200:203], v[240:243], v[44:47], v[200:203]
    v_rcp_f32 v137, v137
    v_rcp_f32 v138, v138
    v_mfma_f32_16x16x32_bf16 v[208:211], v[244:247], v[40:43], v[208:211]
    ds_read_b64_tr_b16 v[236:237], v5 offset:8192
    ds_read_b64_tr_b16 v[238:239], v5 offset:8704
    v_mfma_f32_16x16x32_bf16 v[216:219], v[244:247], v[44:47], v[216:219]
    v_rcp_f32 v139, v139
    v_mul_f32 v136, v136, v152
    v_mul_f32 v137, v137, v153
    v_mul_f32 v138, v138, v154
    s_waitcnt lgkmcnt(8)
    v_mfma_f32_16x16x32_bf16 v[196:199], v[248:251], v[40:43], v[196:199]
    ds_read_b64_tr_b16 v[240:241], v4 offset:4096
    ds_read_b64_tr_b16 v[242:243], v4 offset:4608
    v_mfma_f32_16x16x32_bf16 v[204:207], v[248:251], v[44:47], v[204:207]
    v_mul_f32 v139, v139, v155
    v_cvt_pk_bf16_f32 v148, v136, v137
    v_cvt_pk_bf16_f32 v149, v138, v139
    v_mul_f32 v140, s59, v140
    v_mul_f32 v141, s59, v141
    v_mfma_f32_16x16x32_bf16 v[212:215], v[252:255], v[40:43], v[212:215]
    ds_read_b64_tr_b16 v[244:245], v4 offset:12288
    ds_read_b64_tr_b16 v[246:247], v4 offset:12800
    v_mfma_f32_16x16x32_bf16 v[220:223], v[252:255], v[44:47], v[220:223]
    v_mul_f32 v142, s59, v142
    v_mul_f32 v143, s59, v143
    v_exp_f32 v140, v140
    s_waitcnt lgkmcnt(8)
    v_mfma_f32_16x16x32_bf16 v[192:195], v[224:227], v[48:51], v[192:195]
    ds_read_b64_tr_b16 v[248:249], v5 offset:4096
    ds_read_b64_tr_b16 v[250:251], v5 offset:4608
    v_mfma_f32_16x16x32_bf16 v[200:203], v[224:227], v[52:55], v[200:203]
    v_exp_f32 v141, v141
    v_exp_f32 v142, v142
    v_mfma_f32_16x16x32_bf16 v[208:211], v[228:231], v[48:51], v[208:211]
    ds_read_b64_tr_b16 v[252:253], v5 offset:12288
    ds_read_b64_tr_b16 v[254:255], v5 offset:12800
    v_xor_b32 v4, 81920, v3
    v_mfma_f32_16x16x32_bf16 v[216:219], v[228:231], v[52:55], v[216:219]
    v_exp_f32 v143, v143
    v_add_f32 v140, 1.0, v140
    v_add_f32 v141, 1.0, v141
    v_add_f32 v142, 1.0, v142
    s_waitcnt lgkmcnt(8)
    v_mfma_f32_16x16x32_bf16 v[196:199], v[232:235], v[48:51], v[196:199]
    ds_read_b64_tr_b16 v[224:225], v4 offset:0
    ds_read_b64_tr_b16 v[226:227], v4 offset:512
    v_mfma_f32_16x16x32_bf16 v[204:207], v[232:235], v[52:55], v[204:207]
    v_add_f32 v143, 1.0, v143
    v_rcp_f32 v140, v140
    v_rcp_f32 v141, v141
    v_mfma_f32_16x16x32_bf16 v[212:215], v[236:239], v[48:51], v[212:215]
    ds_read_b64_tr_b16 v[228:229], v4 offset:8192
    ds_read_b64_tr_b16 v[230:231], v4 offset:8704
    v_xor_b32 v5, 81952, v3
    v_mfma_f32_16x16x32_bf16 v[220:223], v[236:239], v[52:55], v[220:223]
    v_rcp_f32 v142, v142
    v_rcp_f32 v143, v143
    s_waitcnt lgkmcnt(8)
    v_mfma_f32_16x16x32_bf16 v[192:195], v[240:243], v[56:59], v[192:195]
    ds_read_b64_tr_b16 v[232:233], v5 offset:0
    ds_read_b64_tr_b16 v[234:235], v5 offset:512
    v_mfma_f32_16x16x32_bf16 v[200:203], v[240:243], v[60:63], v[200:203]
    v_mul_f32 v140, v140, v156
    v_mul_f32 v141, v141, v157
    v_mul_f32 v142, v142, v158
    v_mul_f32 v143, v143, v159
    v_cvt_pk_bf16_f32 v150, v140, v141
    v_mfma_f32_16x16x32_bf16 v[208:211], v[244:247], v[56:59], v[208:211]
    ds_read_b64_tr_b16 v[236:237], v5 offset:8192
    ds_read_b64_tr_b16 v[238:239], v5 offset:8704
    v_xor_b32 v6, 64, v3
    v_mfma_f32_16x16x32_bf16 v[216:219], v[244:247], v[60:63], v[216:219]
    v_cvt_pk_bf16_f32 v151, v142, v143
    buffer_store_dwordx4 v[148:151], v9, s[32:35], s54 offen offset:1024 sc1
    s_waitcnt lgkmcnt(8)
    v_mfma_f32_16x16x32_bf16 v[196:199], v[248:251], v[56:59], v[196:199]
    ds_read_b64_tr_b16 v[240:241], v6 offset:0
    ds_read_b64_tr_b16 v[242:243], v6 offset:512
    v_mfma_f32_16x16x32_bf16 v[204:207], v[248:251], v[60:63], v[204:207]
    v_mul_f32 v160, s59, v160
    v_mul_f32 v161, s59, v161
    v_mul_f32 v162, s59, v162
    v_mul_f32 v163, s59, v163
    v_mfma_f32_16x16x32_bf16 v[212:215], v[252:255], v[56:59], v[212:215]
    ds_read_b64_tr_b16 v[244:245], v6 offset:8192
    ds_read_b64_tr_b16 v[246:247], v6 offset:8704
    v_xor_b32 v7, 96, v3
    v_mfma_f32_16x16x32_bf16 v[220:223], v[252:255], v[60:63], v[220:223]
    v_exp_f32 v160, v160
    v_exp_f32 v161, v161
    s_waitcnt lgkmcnt(8)
    v_mfma_f32_16x16x32_bf16 v[192:195], v[224:227], v[64:67], v[192:195]
    ds_read_b64_tr_b16 v[248:249], v7 offset:0
    ds_read_b64_tr_b16 v[250:251], v7 offset:512
    v_mfma_f32_16x16x32_bf16 v[200:203], v[224:227], v[68:71], v[200:203]
    v_exp_f32 v162, v162
    v_exp_f32 v163, v163
    v_mfma_f32_16x16x32_bf16 v[208:211], v[228:231], v[64:67], v[208:211]
    ds_read_b64_tr_b16 v[252:253], v7 offset:8192
    ds_read_b64_tr_b16 v[254:255], v7 offset:8704
    v_mfma_f32_16x16x32_bf16 v[216:219], v[228:231], v[68:71], v[216:219]
    s_barrier
    v_add_f32 v160, 1.0, v160
    v_add_f32 v161, 1.0, v161
    v_add_f32 v162, 1.0, v162
    v_add_f32 v163, 1.0, v163
    s_waitcnt lgkmcnt(8)
    v_mfma_f32_16x16x32_bf16 v[196:199], v[232:235], v[64:67], v[196:199]
    ds_read_b64_tr_b16 v[224:225], v4 offset:4096
    ds_read_b64_tr_b16 v[226:227], v4 offset:4608
    v_mfma_f32_16x16x32_bf16 v[204:207], v[232:235], v[68:71], v[204:207]
    v_rcp_f32 v160, v160
    v_rcp_f32 v161, v161
    v_mfma_f32_16x16x32_bf16 v[212:215], v[236:239], v[64:67], v[212:215]
    ds_read_b64_tr_b16 v[228:229], v4 offset:12288
    ds_read_b64_tr_b16 v[230:231], v4 offset:12800
    v_mfma_f32_16x16x32_bf16 v[220:223], v[236:239], v[68:71], v[220:223]
    v_rcp_f32 v162, v162
    v_rcp_f32 v163, v163
    s_nop 1
    s_waitcnt lgkmcnt(8)
    v_mfma_f32_16x16x32_bf16 v[128:131], v[240:243], v[16:19], 0
    ds_read_b64_tr_b16 v[232:233], v5 offset:4096
    ds_read_b64_tr_b16 v[234:235], v5 offset:4608
    v_mfma_f32_16x16x32_bf16 v[136:139], v[240:243], v[20:23], 0
    v_mul_f32 v160, v160, v176
    v_mul_f32 v161, v161, v177
    v_mul_f32 v162, v162, v178
    v_mul_f32 v163, v163, v179
    v_mfma_f32_16x16x32_bf16 v[144:147], v[244:247], v[16:19], 0
    ds_read_b64_tr_b16 v[236:237], v5 offset:12288
    ds_read_b64_tr_b16 v[238:239], v5 offset:12800
    v_mfma_f32_16x16x32_bf16 v[152:155], v[244:247], v[20:23], 0
    v_cvt_pk_bf16_f32 v176, v160, v161
    v_cvt_pk_bf16_f32 v177, v162, v163
    v_mul_f32 v164, s59, v164
    v_mul_f32 v165, s59, v165
    s_waitcnt lgkmcnt(8)
    v_mfma_f32_16x16x32_bf16 v[132:135], v[248:251], v[16:19], 0
    ds_read_b64_tr_b16 v[240:241], v6 offset:4096
    ds_read_b64_tr_b16 v[242:243], v6 offset:4608
    v_mfma_f32_16x16x32_bf16 v[140:143], v[248:251], v[20:23], 0
    v_mul_f32 v166, s59, v166
    v_mul_f32 v167, s59, v167
    v_exp_f32 v164, v164
    v_mfma_f32_16x16x32_bf16 v[148:151], v[252:255], v[16:19], 0
    ds_read_b64_tr_b16 v[244:245], v6 offset:12288
    ds_read_b64_tr_b16 v[246:247], v6 offset:12800
    v_mfma_f32_16x16x32_bf16 v[156:159], v[252:255], v[20:23], 0
    v_exp_f32 v165, v165
    v_exp_f32 v166, v166
    s_waitcnt lgkmcnt(8)
    v_mfma_f32_16x16x32_bf16 v[192:195], v[224:227], v[72:75], v[192:195]
    ds_read_b64_tr_b16 v[248:249], v7 offset:4096
    ds_read_b64_tr_b16 v[250:251], v7 offset:4608
    v_mfma_f32_16x16x32_bf16 v[200:203], v[224:227], v[76:79], v[200:203]
    v_exp_f32 v167, v167
    v_add_f32 v164, 1.0, v164
    v_add_f32 v165, 1.0, v165
    v_mfma_f32_16x16x32_bf16 v[208:211], v[228:231], v[72:75], v[208:211]
    ds_read_b64_tr_b16 v[252:253], v7 offset:12288
    ds_read_b64_tr_b16 v[254:255], v7 offset:12800
    v_mfma_f32_16x16x32_bf16 v[216:219], v[228:231], v[76:79], v[216:219]
    s_barrier
    v_xor_b32 v4, 49152, v3
    v_add_f32 v166, 1.0, v166
    v_add_f32 v167, 1.0, v167
    v_rcp_f32 v164, v164
    s_waitcnt lgkmcnt(8)
    v_mfma_f32_16x16x32_bf16 v[196:199], v[232:235], v[72:75], v[196:199]
    ds_read_b64_tr_b16 v[224:225], v4 offset:0
    ds_read_b64_tr_b16 v[226:227], v4 offset:512
    v_mfma_f32_16x16x32_bf16 v[204:207], v[232:235], v[76:79], v[204:207]
    v_rcp_f32 v165, v165
    v_rcp_f32 v166, v166
    v_mfma_f32_16x16x32_bf16 v[212:215], v[236:239], v[72:75], v[212:215]
    ds_read_b64_tr_b16 v[228:229], v4 offset:8192
    ds_read_b64_tr_b16 v[230:231], v4 offset:8704
    v_xor_b32 v5, 49184, v3
    v_mfma_f32_16x16x32_bf16 v[220:223], v[236:239], v[76:79], v[220:223]
    v_rcp_f32 v167, v167
    v_mul_f32 v164, v164, v180
    v_mul_f32 v165, v165, v181
    s_waitcnt lgkmcnt(8)
    v_mfma_f32_16x16x32_bf16 v[128:131], v[240:243], v[24:27], v[128:131]
    ds_read_b64_tr_b16 v[232:233], v5 offset:0
    ds_read_b64_tr_b16 v[234:235], v5 offset:512
    v_mfma_f32_16x16x32_bf16 v[136:139], v[240:243], v[28:31], v[136:139]
    v_mul_f32 v166, v166, v182
    v_mul_f32 v167, v167, v183
    v_cvt_pk_bf16_f32 v178, v164, v165
    v_cvt_pk_bf16_f32 v179, v166, v167
    v_mfma_f32_16x16x32_bf16 v[144:147], v[244:247], v[24:27], v[144:147]
    ds_read_b64_tr_b16 v[236:237], v5 offset:8192
    ds_read_b64_tr_b16 v[238:239], v5 offset:8704
    v_xor_b32 v6, 16448, v3
    v_mfma_f32_16x16x32_bf16 v[152:155], v[244:247], v[28:31], v[152:155]
    buffer_store_dwordx4 v[176:179], v9, s[32:35], s54 offen offset:2048 sc1
    v_mul_f32 v168, s59, v168
    s_waitcnt lgkmcnt(8)
    v_mfma_f32_16x16x32_bf16 v[132:135], v[248:251], v[24:27], v[132:135]
    ds_read_b64_tr_b16 v[240:241], v6 offset:0
    ds_read_b64_tr_b16 v[242:243], v6 offset:512
    v_mfma_f32_16x16x32_bf16 v[140:143], v[248:251], v[28:31], v[140:143]
    v_mul_f32 v169, s59, v169
    v_mul_f32 v170, s59, v170
    v_mul_f32 v171, s59, v171
    v_mfma_f32_16x16x32_bf16 v[148:151], v[252:255], v[24:27], v[148:151]
    ds_read_b64_tr_b16 v[244:245], v6 offset:8192
    ds_read_b64_tr_b16 v[246:247], v6 offset:8704
    v_xor_b32 v7, 16480, v3
    v_mfma_f32_16x16x32_bf16 v[156:159], v[252:255], v[28:31], v[156:159]
    v_exp_f32 v168, v168
    v_exp_f32 v169, v169
    s_waitcnt lgkmcnt(8)
    v_mfma_f32_16x16x32_bf16 v[192:195], v[224:227], v[80:83], v[192:195]
    ds_read_b64_tr_b16 v[248:249], v7 offset:0
    ds_read_b64_tr_b16 v[250:251], v7 offset:512
    v_mfma_f32_16x16x32_bf16 v[200:203], v[224:227], v[84:87], v[200:203]
    v_exp_f32 v170, v170
    v_exp_f32 v171, v171
    v_add_f32 v168, 1.0, v168
    v_mfma_f32_16x16x32_bf16 v[208:211], v[228:231], v[80:83], v[208:211]
    ds_read_b64_tr_b16 v[252:253], v7 offset:8192
    ds_read_b64_tr_b16 v[254:255], v7 offset:8704
    v_mfma_f32_16x16x32_bf16 v[216:219], v[228:231], v[84:87], v[216:219]
    v_add_f32 v169, 1.0, v169
    v_add_f32 v170, 1.0, v170
    v_add_f32 v171, 1.0, v171
    s_waitcnt lgkmcnt(8)
    v_mfma_f32_16x16x32_bf16 v[196:199], v[232:235], v[80:83], v[196:199]
    ds_read_b64_tr_b16 v[224:225], v4 offset:4096
    ds_read_b64_tr_b16 v[226:227], v4 offset:4608
    v_mfma_f32_16x16x32_bf16 v[204:207], v[232:235], v[84:87], v[204:207]
    v_rcp_f32 v168, v168
    v_rcp_f32 v169, v169
    v_mfma_f32_16x16x32_bf16 v[212:215], v[236:239], v[80:83], v[212:215]
    ds_read_b64_tr_b16 v[228:229], v4 offset:12288
    ds_read_b64_tr_b16 v[230:231], v4 offset:12800
    v_mfma_f32_16x16x32_bf16 v[220:223], v[236:239], v[84:87], v[220:223]
    v_rcp_f32 v170, v170
    v_rcp_f32 v171, v171
    v_mul_f32 v168, v168, v184
    s_waitcnt vmcnt(1)
    s_mov_b64 exec, 1
    buffer_store_dwordx2 v[12:13], v14, s[32:35], 0 offen offset:0 sc0 sc1
    s_mov_b64 exec, -1
    s_waitcnt lgkmcnt(8)
    v_mfma_f32_16x16x32_bf16 v[128:131], v[240:243], v[32:35], v[128:131]
    ds_read_b64_tr_b16 v[232:233], v5 offset:4096
    ds_read_b64_tr_b16 v[234:235], v5 offset:4608
    v_mfma_f32_16x16x32_bf16 v[136:139], v[240:243], v[36:39], v[136:139]
    v_mul_f32 v169, v169, v185
    v_mul_f32 v170, v170, v186
    v_mul_f32 v171, v171, v187
    v_cvt_pk_bf16_f32 v180, v168, v169
    v_mfma_f32_16x16x32_bf16 v[144:147], v[244:247], v[32:35], v[144:147]
    ds_read_b64_tr_b16 v[236:237], v5 offset:12288
    ds_read_b64_tr_b16 v[238:239], v5 offset:12800
    v_mfma_f32_16x16x32_bf16 v[152:155], v[244:247], v[36:39], v[152:155]
    v_cvt_pk_bf16_f32 v181, v170, v171
    v_mul_f32 v172, s59, v172
    v_mul_f32 v173, s59, v173
    v_mul_f32 v174, s59, v174
    s_waitcnt lgkmcnt(8)
    v_mfma_f32_16x16x32_bf16 v[132:135], v[248:251], v[32:35], v[132:135]
    ds_read_b64_tr_b16 v[240:241], v6 offset:4096
    ds_read_b64_tr_b16 v[242:243], v6 offset:4608
    v_mfma_f32_16x16x32_bf16 v[140:143], v[248:251], v[36:39], v[140:143]
    v_mul_f32 v175, s59, v175
    v_exp_f32 v172, v172
    v_mfma_f32_16x16x32_bf16 v[148:151], v[252:255], v[32:35], v[148:151]
    ds_read_b64_tr_b16 v[244:245], v6 offset:12288
    ds_read_b64_tr_b16 v[246:247], v6 offset:12800
    v_mfma_f32_16x16x32_bf16 v[156:159], v[252:255], v[36:39], v[156:159]
    v_exp_f32 v173, v173
    v_exp_f32 v174, v174
    s_waitcnt lgkmcnt(8)
    v_mfma_f32_16x16x32_bf16 v[192:195], v[224:227], v[88:91], v[192:195]
    ds_read_b64_tr_b16 v[248:249], v7 offset:4096
    ds_read_b64_tr_b16 v[250:251], v7 offset:4608
    v_mfma_f32_16x16x32_bf16 v[200:203], v[224:227], v[92:95], v[200:203]
    v_exp_f32 v175, v175
    v_add_f32 v172, 1.0, v172
    v_add_f32 v173, 1.0, v173
    v_add_f32 v174, 1.0, v174
    v_mfma_f32_16x16x32_bf16 v[208:211], v[228:231], v[88:91], v[208:211]
    ds_read_b64_tr_b16 v[252:253], v7 offset:12288
    ds_read_b64_tr_b16 v[254:255], v7 offset:12800
    v_mfma_f32_16x16x32_bf16 v[216:219], v[228:231], v[92:95], v[216:219]
    s_barrier
    v_xor_b32 v4, 131072, v3
    v_add_f32 v175, 1.0, v175
    v_rcp_f32 v172, v172
    s_waitcnt lgkmcnt(8)
    v_mfma_f32_16x16x32_bf16 v[196:199], v[232:235], v[88:91], v[196:199]
    ds_read_b64_tr_b16 v[224:225], v4 offset:0
    ds_read_b64_tr_b16 v[226:227], v4 offset:512
    v_mfma_f32_16x16x32_bf16 v[204:207], v[232:235], v[92:95], v[204:207]
    v_rcp_f32 v173, v173
    v_rcp_f32 v174, v174
    v_mfma_f32_16x16x32_bf16 v[212:215], v[236:239], v[88:91], v[212:215]
    ds_read_b64_tr_b16 v[228:229], v4 offset:8192
    ds_read_b64_tr_b16 v[230:231], v4 offset:8704
    v_xor_b32 v5, 131104, v3
    v_mfma_f32_16x16x32_bf16 v[220:223], v[236:239], v[92:95], v[220:223]
    v_rcp_f32 v175, v175
    v_mul_f32 v172, v172, v188
    v_mul_f32 v173, v173, v189
    v_mul_f32 v174, v174, v190
    s_waitcnt lgkmcnt(8)
    v_mfma_f32_16x16x32_bf16 v[128:131], v[240:243], v[40:43], v[128:131]
    ds_read_b64_tr_b16 v[232:233], v5 offset:0
    ds_read_b64_tr_b16 v[234:235], v5 offset:512
    v_mfma_f32_16x16x32_bf16 v[136:139], v[240:243], v[44:47], v[136:139]
    v_mul_f32 v175, v175, v191
    v_cvt_pk_bf16_f32 v182, v172, v173
    v_cvt_pk_bf16_f32 v183, v174, v175
    v_mfma_f32_16x16x32_bf16 v[144:147], v[244:247], v[40:43], v[144:147]
    ds_read_b64_tr_b16 v[236:237], v5 offset:8192
    ds_read_b64_tr_b16 v[238:239], v5 offset:8704
    v_xor_b32 v6, 32832, v3
    v_mfma_f32_16x16x32_bf16 v[152:155], v[244:247], v[44:47], v[152:155]
    buffer_store_dwordx4 v[180:183], v9, s[32:35], s54 offen offset:3072 sc1
    s_waitcnt lgkmcnt(8)
    v_mfma_f32_16x16x32_bf16 v[132:135], v[248:251], v[40:43], v[132:135]
    ds_read_b64_tr_b16 v[240:241], v6 offset:0
    ds_read_b64_tr_b16 v[242:243], v6 offset:512
    v_mfma_f32_16x16x32_bf16 v[140:143], v[248:251], v[44:47], v[140:143]
    ds_read_b64_tr_b16 v[244:245], v6 offset:8192
    v_mfma_f32_16x16x32_bf16 v[148:151], v[252:255], v[40:43], v[148:151]
    ds_read_b64_tr_b16 v[246:247], v6 offset:8704
    v_xor_b32 v7, 32864, v3
    v_mfma_f32_16x16x32_bf16 v[156:159], v[252:255], v[44:47], v[156:159]
    ds_read_b64_tr_b16 v[248:249], v7 offset:0
    s_waitcnt lgkmcnt(9)
    v_mfma_f32_16x16x32_bf16 v[192:195], v[224:227], v[96:99], v[192:195]
    ds_read_b64_tr_b16 v[250:251], v7 offset:512
    v_mfma_f32_16x16x32_bf16 v[200:203], v[224:227], v[100:103], v[200:203]
    ds_read_b64_tr_b16 v[252:253], v7 offset:8192
    v_mfma_f32_16x16x32_bf16 v[208:211], v[228:231], v[96:99], v[208:211]
    ds_read_b64_tr_b16 v[254:255], v7 offset:8704
    v_mfma_f32_16x16x32_bf16 v[216:219], v[228:231], v[100:103], v[216:219]
    ds_read_b64_tr_b16 v[224:225], v4 offset:4096
    s_waitcnt lgkmcnt(9)
    v_mfma_f32_16x16x32_bf16 v[196:199], v[232:235], v[96:99], v[196:199]
    ds_read_b64_tr_b16 v[226:227], v4 offset:4608
    v_mfma_f32_16x16x32_bf16 v[204:207], v[232:235], v[100:103], v[204:207]
    ds_read_b64_tr_b16 v[228:229], v4 offset:12288
    v_mfma_f32_16x16x32_bf16 v[212:215], v[236:239], v[96:99], v[212:215]
    ds_read_b64_tr_b16 v[230:231], v4 offset:12800
    v_mfma_f32_16x16x32_bf16 v[220:223], v[236:239], v[100:103], v[220:223]
    ds_read_b64_tr_b16 v[232:233], v5 offset:4096
    s_waitcnt lgkmcnt(9)
    v_mfma_f32_16x16x32_bf16 v[128:131], v[240:243], v[48:51], v[128:131]
    ds_read_b64_tr_b16 v[234:235], v5 offset:4608
    v_mfma_f32_16x16x32_bf16 v[136:139], v[240:243], v[52:55], v[136:139]
    ds_read_b64_tr_b16 v[236:237], v5 offset:12288
    v_mfma_f32_16x16x32_bf16 v[144:147], v[244:247], v[48:51], v[144:147]
    ds_read_b64_tr_b16 v[238:239], v5 offset:12800
    v_mfma_f32_16x16x32_bf16 v[152:155], v[244:247], v[52:55], v[152:155]
    ds_read_b64_tr_b16 v[240:241], v6 offset:4096
    s_waitcnt lgkmcnt(9)
    v_mfma_f32_16x16x32_bf16 v[132:135], v[248:251], v[48:51], v[132:135]
    ds_read_b64_tr_b16 v[242:243], v6 offset:4608
    v_mfma_f32_16x16x32_bf16 v[140:143], v[248:251], v[52:55], v[140:143]
    ds_read_b64_tr_b16 v[244:245], v6 offset:12288
    v_mfma_f32_16x16x32_bf16 v[148:151], v[252:255], v[48:51], v[148:151]
    ds_read_b64_tr_b16 v[246:247], v6 offset:12800
    v_mfma_f32_16x16x32_bf16 v[156:159], v[252:255], v[52:55], v[156:159]
    ds_read_b64_tr_b16 v[248:249], v7 offset:4096
    s_waitcnt lgkmcnt(9)
    v_mfma_f32_16x16x32_bf16 v[192:195], v[224:227], v[104:107], v[192:195]
    ds_read_b64_tr_b16 v[250:251], v7 offset:4608
    v_mfma_f32_16x16x32_bf16 v[200:203], v[224:227], v[108:111], v[200:203]
    ds_read_b64_tr_b16 v[252:253], v7 offset:12288
    v_mfma_f32_16x16x32_bf16 v[208:211], v[228:231], v[104:107], v[208:211]
    ds_read_b64_tr_b16 v[254:255], v7 offset:12800
    v_xor_b32 v4, 98304, v3
    v_mfma_f32_16x16x32_bf16 v[216:219], v[228:231], v[108:111], v[216:219]
    s_barrier
    s_waitcnt lgkmcnt(8)
    v_mfma_f32_16x16x32_bf16 v[196:199], v[232:235], v[104:107], v[196:199]
    ds_read_b64_tr_b16 v[224:225], v4 offset:0
    ds_read_b64_tr_b16 v[226:227], v4 offset:512
    v_mfma_f32_16x16x32_bf16 v[204:207], v[232:235], v[108:111], v[204:207]
    ds_read_b64_tr_b16 v[228:229], v4 offset:8192
    v_mfma_f32_16x16x32_bf16 v[212:215], v[236:239], v[104:107], v[212:215]
    ds_read_b64_tr_b16 v[230:231], v4 offset:8704
    v_xor_b32 v5, 98336, v3
    v_mfma_f32_16x16x32_bf16 v[220:223], v[236:239], v[108:111], v[220:223]
    ds_read_b64_tr_b16 v[232:233], v5 offset:0
    s_waitcnt lgkmcnt(9)
    v_mfma_f32_16x16x32_bf16 v[128:131], v[240:243], v[56:59], v[128:131]
    ds_read_b64_tr_b16 v[234:235], v5 offset:512
    v_mfma_f32_16x16x32_bf16 v[136:139], v[240:243], v[60:63], v[136:139]
    ds_read_b64_tr_b16 v[236:237], v5 offset:8192
    v_mfma_f32_16x16x32_bf16 v[144:147], v[244:247], v[56:59], v[144:147]
    ds_read_b64_tr_b16 v[238:239], v5 offset:8704
    v_xor_b32 v6, 81984, v3
    v_mfma_f32_16x16x32_bf16 v[152:155], v[244:247], v[60:63], v[152:155]
    ds_read_b64_tr_b16 v[240:241], v6 offset:0
    s_waitcnt lgkmcnt(9)
    v_mfma_f32_16x16x32_bf16 v[132:135], v[248:251], v[56:59], v[132:135]
    ds_read_b64_tr_b16 v[242:243], v6 offset:512
    v_mfma_f32_16x16x32_bf16 v[140:143], v[248:251], v[60:63], v[140:143]
    ds_read_b64_tr_b16 v[244:245], v6 offset:8192
    v_mfma_f32_16x16x32_bf16 v[148:151], v[252:255], v[56:59], v[148:151]
    ds_read_b64_tr_b16 v[246:247], v6 offset:8704
    v_xor_b32 v7, 82016, v3
    v_mfma_f32_16x16x32_bf16 v[156:159], v[252:255], v[60:63], v[156:159]
    ds_read_b64_tr_b16 v[248:249], v7 offset:0
    s_waitcnt lgkmcnt(9)
    v_mfma_f32_16x16x32_bf16 v[192:195], v[224:227], v[112:115], v[192:195]
    ds_read_b64_tr_b16 v[250:251], v7 offset:512
    v_mfma_f32_16x16x32_bf16 v[200:203], v[224:227], v[116:119], v[200:203]
    ds_read_b64_tr_b16 v[252:253], v7 offset:8192
    v_mfma_f32_16x16x32_bf16 v[208:211], v[228:231], v[112:115], v[208:211]
    ds_read_b64_tr_b16 v[254:255], v7 offset:8704
    v_mfma_f32_16x16x32_bf16 v[216:219], v[228:231], v[116:119], v[216:219]
    ds_read_b64_tr_b16 v[224:225], v4 offset:4096
    s_waitcnt lgkmcnt(9)
    v_mfma_f32_16x16x32_bf16 v[196:199], v[232:235], v[112:115], v[196:199]
    ds_read_b64_tr_b16 v[226:227], v4 offset:4608
    v_mfma_f32_16x16x32_bf16 v[204:207], v[232:235], v[116:119], v[204:207]
    ds_read_b64_tr_b16 v[228:229], v4 offset:12288
    v_mfma_f32_16x16x32_bf16 v[212:215], v[236:239], v[112:115], v[212:215]
    ds_read_b64_tr_b16 v[230:231], v4 offset:12800
    v_mfma_f32_16x16x32_bf16 v[220:223], v[236:239], v[116:119], v[220:223]
    ds_read_b64_tr_b16 v[232:233], v5 offset:4096
    s_waitcnt vmcnt(0)
    s_mov_b64 exec, 1
    buffer_store_dwordx2 v[12:13], v14, s[32:35], 0 offen offset:64 sc0 sc1
    s_mov_b64 exec, -1
    s_waitcnt lgkmcnt(9)
    v_mfma_f32_16x16x32_bf16 v[128:131], v[240:243], v[64:67], v[128:131]
    ds_read_b64_tr_b16 v[234:235], v5 offset:4608
    v_mfma_f32_16x16x32_bf16 v[136:139], v[240:243], v[68:71], v[136:139]
    ds_read_b64_tr_b16 v[236:237], v5 offset:12288
    v_mfma_f32_16x16x32_bf16 v[144:147], v[244:247], v[64:67], v[144:147]
    ds_read_b64_tr_b16 v[238:239], v5 offset:12800
    v_mfma_f32_16x16x32_bf16 v[152:155], v[244:247], v[68:71], v[152:155]
    ds_read_b64_tr_b16 v[240:241], v6 offset:4096
    s_waitcnt lgkmcnt(9)
    v_mfma_f32_16x16x32_bf16 v[132:135], v[248:251], v[64:67], v[132:135]
    ds_read_b64_tr_b16 v[242:243], v6 offset:4608
    v_mfma_f32_16x16x32_bf16 v[140:143], v[248:251], v[68:71], v[140:143]
    ds_read_b64_tr_b16 v[244:245], v6 offset:12288
    v_mfma_f32_16x16x32_bf16 v[148:151], v[252:255], v[64:67], v[148:151]
    ds_read_b64_tr_b16 v[246:247], v6 offset:12800
    v_mfma_f32_16x16x32_bf16 v[156:159], v[252:255], v[68:71], v[156:159]
    ds_read_b64_tr_b16 v[248:249], v7 offset:4096
    s_waitcnt lgkmcnt(9)
    v_mfma_f32_16x16x32_bf16 v[192:195], v[224:227], v[120:123], v[192:195]
    ds_read_b64_tr_b16 v[250:251], v7 offset:4608
    v_mfma_f32_16x16x32_bf16 v[200:203], v[224:227], v[124:127], v[200:203]
    ds_read_b64_tr_b16 v[252:253], v7 offset:12288
    v_mfma_f32_16x16x32_bf16 v[208:211], v[228:231], v[120:123], v[208:211]
    ds_read_b64_tr_b16 v[254:255], v7 offset:12800
    v_xor_b32 v6, 49216, v3
    v_mfma_f32_16x16x32_bf16 v[216:219], v[228:231], v[124:127], v[216:219]
    s_barrier
    s_waitcnt lgkmcnt(8)
    v_mfma_f32_16x16x32_bf16 v[196:199], v[232:235], v[120:123], v[196:199]
    ds_read_b64_tr_b16 v[224:225], v6 offset:0
    ds_read_b64_tr_b16 v[226:227], v6 offset:512
    v_mfma_f32_16x16x32_bf16 v[204:207], v[232:235], v[124:127], v[204:207]
    ds_read_b64_tr_b16 v[228:229], v6 offset:8192
    v_mfma_f32_16x16x32_bf16 v[212:215], v[236:239], v[120:123], v[212:215]
    ds_read_b64_tr_b16 v[230:231], v6 offset:8704
    v_xor_b32 v7, 49248, v3
    v_mfma_f32_16x16x32_bf16 v[220:223], v[236:239], v[124:127], v[220:223]
    ds_read_b64_tr_b16 v[232:233], v7 offset:0
    s_waitcnt lgkmcnt(9)
    v_mfma_f32_16x16x32_bf16 v[128:131], v[240:243], v[72:75], v[128:131]
    ds_read_b64_tr_b16 v[234:235], v7 offset:512
    v_mfma_f32_16x16x32_bf16 v[136:139], v[240:243], v[76:79], v[136:139]
    ds_read_b64_tr_b16 v[236:237], v7 offset:8192
    v_mfma_f32_16x16x32_bf16 v[144:147], v[244:247], v[72:75], v[144:147]
    ds_read_b64_tr_b16 v[238:239], v7 offset:8704
    v_mfma_f32_16x16x32_bf16 v[152:155], v[244:247], v[76:79], v[152:155]
    ds_read_b64_tr_b16 v[240:241], v6 offset:4096
    s_waitcnt lgkmcnt(9)
    v_mfma_f32_16x16x32_bf16 v[132:135], v[248:251], v[72:75], v[132:135]
    ds_read_b64_tr_b16 v[242:243], v6 offset:4608
    ds_read_b64_tr_b16 v[244:245], v6 offset:12288
    v_mfma_f32_16x16x32_bf16 v[140:143], v[248:251], v[76:79], v[140:143]
    v_mul_f32 v192, s59, v192
    v_mul_f32 v193, s59, v193
    v_mul_f32 v194, s59, v194
    v_mul_f32 v195, s59, v195
    v_exp_f32 v192, v192
    v_mfma_f32_16x16x32_bf16 v[148:151], v[252:255], v[72:75], v[148:151]
    ds_read_b64_tr_b16 v[246:247], v6 offset:12800
    ds_read_b64_tr_b16 v[248:249], v7 offset:4096
    v_mfma_f32_16x16x32_bf16 v[156:159], v[252:255], v[76:79], v[156:159]
    v_exp_f32 v193, v193
    v_exp_f32 v194, v194
    s_waitcnt lgkmcnt(9)
    v_mfma_f32_16x16x32_bf16 v[128:131], v[224:227], v[80:83], v[128:131]
    ds_read_b64_tr_b16 v[250:251], v7 offset:4608
    ds_read_b64_tr_b16 v[252:253], v7 offset:12288
    v_mfma_f32_16x16x32_bf16 v[136:139], v[224:227], v[84:87], v[136:139]
    v_exp_f32 v195, v195
    v_add_f32 v192, 1.0, v192
    v_add_f32 v193, 1.0, v193
    v_add_f32 v194, 1.0, v194
    v_add_f32 v195, 1.0, v195
    v_mfma_f32_16x16x32_bf16 v[144:147], v[228:231], v[80:83], v[144:147]
    ds_read_b64_tr_b16 v[254:255], v7 offset:12800
    v_xor_b32 v6, 131136, v3
    v_rcp_f32 v192, v192
    v_mfma_f32_16x16x32_bf16 v[152:155], v[228:231], v[84:87], v[152:155]
    s_barrier
    v_rcp_f32 v193, v193
    v_rcp_f32 v194, v194
    s_waitcnt lgkmcnt(8)
    v_mfma_f32_16x16x32_bf16 v[132:135], v[232:235], v[80:83], v[132:135]
    ds_read_b64_tr_b16 v[224:225], v6 offset:0
    ds_read_b64_tr_b16 v[226:227], v6 offset:512
    v_mfma_f32_16x16x32_bf16 v[140:143], v[232:235], v[84:87], v[140:143]
    v_rcp_f32 v195, v195
    v_mul_f32 v192, v192, v208
    v_mul_f32 v193, v193, v209
    v_mul_f32 v194, v194, v210
    v_mul_f32 v195, v195, v211
    v_mfma_f32_16x16x32_bf16 v[148:151], v[236:239], v[80:83], v[148:151]
    ds_read_b64_tr_b16 v[228:229], v6 offset:8192
    ds_read_b64_tr_b16 v[230:231], v6 offset:8704
    v_xor_b32 v7, 131168, v3
    v_mfma_f32_16x16x32_bf16 v[156:159], v[236:239], v[84:87], v[156:159]
    v_cvt_pk_bf16_f32 v208, v192, v193
    v_cvt_pk_bf16_f32 v209, v194, v195
    v_mul_f32 v196, s59, v196
    v_mul_f32 v197, s59, v197
    v_mul_f32 v198, s59, v198
    s_waitcnt lgkmcnt(8)
    v_mfma_f32_16x16x32_bf16 v[128:131], v[240:243], v[88:91], v[128:131]
    ds_read_b64_tr_b16 v[232:233], v7 offset:0
    ds_read_b64_tr_b16 v[234:235], v7 offset:512
    v_mfma_f32_16x16x32_bf16 v[136:139], v[240:243], v[92:95], v[136:139]
    v_mul_f32 v199, s59, v199
    v_exp_f32 v196, v196
    v_exp_f32 v197, v197
    v_mfma_f32_16x16x32_bf16 v[144:147], v[244:247], v[88:91], v[144:147]
    ds_read_b64_tr_b16 v[236:237], v7 offset:8192
    ds_read_b64_tr_b16 v[238:239], v7 offset:8704
    v_mfma_f32_16x16x32_bf16 v[152:155], v[244:247], v[92:95], v[152:155]
    v_exp_f32 v198, v198
    v_exp_f32 v199, v199
    v_add_f32 v196, 1.0, v196
    v_add_f32 v197, 1.0, v197
    s_waitcnt lgkmcnt(8)
    v_mfma_f32_16x16x32_bf16 v[132:135], v[248:251], v[88:91], v[132:135]
    ds_read_b64_tr_b16 v[240:241], v6 offset:4096
    ds_read_b64_tr_b16 v[242:243], v6 offset:4608
    v_mfma_f32_16x16x32_bf16 v[140:143], v[248:251], v[92:95], v[140:143]
    v_add_f32 v198, 1.0, v198
    v_add_f32 v199, 1.0, v199
    v_rcp_f32 v196, v196
    v_rcp_f32 v197, v197
    v_mfma_f32_16x16x32_bf16 v[148:151], v[252:255], v[88:91], v[148:151]
    ds_read_b64_tr_b16 v[244:245], v6 offset:12288
    ds_read_b64_tr_b16 v[246:247], v6 offset:12800
    v_mfma_f32_16x16x32_bf16 v[156:159], v[252:255], v[92:95], v[156:159]
    v_rcp_f32 v198, v198
    v_rcp_f32 v199, v199
    v_mul_f32 v196, v196, v212
    s_waitcnt lgkmcnt(8)
    v_mfma_f32_16x16x32_bf16 v[128:131], v[224:227], v[96:99], v[128:131]
    ds_read_b64_tr_b16 v[248:249], v7 offset:4096
    ds_read_b64_tr_b16 v[250:251], v7 offset:4608
    v_mfma_f32_16x16x32_bf16 v[136:139], v[224:227], v[100:103], v[136:139]
    v_mul_f32 v197, v197, v213
    v_mul_f32 v198, v198, v214
    v_mul_f32 v199, v199, v215
    v_cvt_pk_bf16_f32 v210, v196, v197
    v_cvt_pk_bf16_f32 v211, v198, v199
    v_mfma_f32_16x16x32_bf16 v[144:147], v[228:231], v[96:99], v[144:147]
    ds_read_b64_tr_b16 v[252:253], v7 offset:12288
    ds_read_b64_tr_b16 v[254:255], v7 offset:12800
    v_mfma_f32_16x16x32_bf16 v[152:155], v[228:231], v[100:103], v[152:155]
    s_barrier
    v_xor_b32 v6, 98368, v3
    buffer_store_dwordx4 v[208:211], v11, s[32:35], s54 offen offset:0 sc1
    v_mul_f32 v200, s59, v200
    v_mul_f32 v201, s59, v201
    v_mul_f32 v202, s59, v202
    s_waitcnt lgkmcnt(8)
    v_mfma_f32_16x16x32_bf16 v[132:135], v[232:235], v[96:99], v[132:135]
    ds_read_b64_tr_b16 v[224:225], v6 offset:0
    ds_read_b64_tr_b16 v[226:227], v6 offset:512
    v_mfma_f32_16x16x32_bf16 v[140:143], v[232:235], v[100:103], v[140:143]
    v_mul_f32 v203, s59, v203
    v_exp_f32 v200, v200
    v_exp_f32 v201, v201
    v_mfma_f32_16x16x32_bf16 v[148:151], v[236:239], v[96:99], v[148:151]
    ds_read_b64_tr_b16 v[228:229], v6 offset:8192
    ds_read_b64_tr_b16 v[230:231], v6 offset:8704
    v_xor_b32 v7, 98400, v3
    v_mfma_f32_16x16x32_bf16 v[156:159], v[236:239], v[100:103], v[156:159]
    v_exp_f32 v202, v202
    v_exp_f32 v203, v203
    v_add_f32 v200, 1.0, v200
    v_add_f32 v201, 1.0, v201
    s_waitcnt lgkmcnt(8)
    v_mfma_f32_16x16x32_bf16 v[128:131], v[240:243], v[104:107], v[128:131]
    ds_read_b64_tr_b16 v[232:233], v7 offset:0
    ds_read_b64_tr_b16 v[234:235], v7 offset:512
    v_mfma_f32_16x16x32_bf16 v[136:139], v[240:243], v[108:111], v[136:139]
    v_add_f32 v202, 1.0, v202
    v_add_f32 v203, 1.0, v203
    v_rcp_f32 v200, v200
    v_rcp_f32 v201, v201
    v_mfma_f32_16x16x32_bf16 v[144:147], v[244:247], v[104:107], v[144:147]
    ds_read_b64_tr_b16 v[236:237], v7 offset:8192
    ds_read_b64_tr_b16 v[238:239], v7 offset:8704
    v_mfma_f32_16x16x32_bf16 v[152:155], v[244:247], v[108:111], v[152:155]
    v_rcp_f32 v202, v202
    v_rcp_f32 v203, v203
    v_mul_f32 v200, v200, v216
    s_waitcnt lgkmcnt(8)
    v_mfma_f32_16x16x32_bf16 v[132:135], v[248:251], v[104:107], v[132:135]
    ds_read_b64_tr_b16 v[240:241], v6 offset:4096
    ds_read_b64_tr_b16 v[242:243], v6 offset:4608
    v_mfma_f32_16x16x32_bf16 v[140:143], v[248:251], v[108:111], v[140:143]
    v_mul_f32 v201, v201, v217
    v_mul_f32 v202, v202, v218
    v_mul_f32 v203, v203, v219
    v_cvt_pk_bf16_f32 v212, v200, v201
    v_cvt_pk_bf16_f32 v213, v202, v203
    v_mul_f32 v204, s59, v204
    v_mfma_f32_16x16x32_bf16 v[148:151], v[252:255], v[104:107], v[148:151]
    ds_read_b64_tr_b16 v[244:245], v6 offset:12288
    ds_read_b64_tr_b16 v[246:247], v6 offset:12800
    v_mfma_f32_16x16x32_bf16 v[156:159], v[252:255], v[108:111], v[156:159]
    v_mul_f32 v205, s59, v205
    v_mul_f32 v206, s59, v206
    v_mul_f32 v207, s59, v207
    v_exp_f32 v204, v204
    s_waitcnt lgkmcnt(8)
    v_mfma_f32_16x16x32_bf16 v[128:131], v[224:227], v[112:115], v[128:131]
    ds_read_b64_tr_b16 v[248:249], v7 offset:4096
    ds_read_b64_tr_b16 v[250:251], v7 offset:4608
    v_mfma_f32_16x16x32_bf16 v[136:139], v[224:227], v[116:119], v[136:139]
    v_exp_f32 v205, v205
    v_exp_f32 v206, v206
    v_exp_f32 v207, v207
    v_mfma_f32_16x16x32_bf16 v[144:147], v[228:231], v[112:115], v[144:147]
    ds_read_b64_tr_b16 v[252:253], v7 offset:12288
    ds_read_b64_tr_b16 v[254:255], v7 offset:12800
    v_mfma_f32_16x16x32_bf16 v[152:155], v[228:231], v[116:119], v[152:155]
    v_add_f32 v204, 1.0, v204
    v_add_f32 v205, 1.0, v205
    v_add_f32 v206, 1.0, v206
    v_add_f32 v207, 1.0, v207
    s_waitcnt lgkmcnt(8)
    v_mfma_f32_16x16x32_bf16 v[132:135], v[232:235], v[112:115], v[132:135]
    v_rcp_f32 v204, v204
    v_rcp_f32 v205, v205
    v_mfma_f32_16x16x32_bf16 v[140:143], v[232:235], v[116:119], v[140:143]
    v_rcp_f32 v206, v206
    v_mfma_f32_16x16x32_bf16 v[148:151], v[236:239], v[112:115], v[148:151]
    v_rcp_f32 v207, v207
    v_mul_f32 v204, v204, v220
    v_mfma_f32_16x16x32_bf16 v[156:159], v[236:239], v[116:119], v[156:159]
    v_mul_f32 v205, v205, v221
    v_mul_f32 v206, v206, v222
    v_mul_f32 v207, v207, v223
    s_waitcnt lgkmcnt(4)
    v_mfma_f32_16x16x32_bf16 v[128:131], v[240:243], v[120:123], v[128:131]
    v_cvt_pk_bf16_f32 v214, v204, v205
    v_cvt_pk_bf16_f32 v215, v206, v207
    v_mfma_f32_16x16x32_bf16 v[136:139], v[240:243], v[124:127], v[136:139]
    buffer_store_dwordx4 v[212:215], v11, s[32:35], s54 offen offset:1024 sc1
    v_mfma_f32_16x16x32_bf16 v[144:147], v[244:247], v[120:123], v[144:147]
    v_mfma_f32_16x16x32_bf16 v[152:155], v[244:247], v[124:127], v[152:155]
    s_waitcnt lgkmcnt(0)
    v_mfma_f32_16x16x32_bf16 v[132:135], v[248:251], v[120:123], v[132:135]
    v_mfma_f32_16x16x32_bf16 v[140:143], v[248:251], v[124:127], v[140:143]
    v_mfma_f32_16x16x32_bf16 v[148:151], v[252:255], v[120:123], v[148:151]
    v_mfma_f32_16x16x32_bf16 v[156:159], v[252:255], v[124:127], v[156:159]
    s_nop 7
    v_mul_f32 v128, s59, v128
    v_mul_f32 v129, s59, v129
    v_mul_f32 v130, s59, v130
    v_mul_f32 v131, s59, v131
    v_exp_f32 v128, v128
    v_exp_f32 v129, v129
    v_exp_f32 v130, v130
    v_exp_f32 v131, v131
    v_add_f32 v128, 1.0, v128
    v_add_f32 v129, 1.0, v129
    v_add_f32 v130, 1.0, v130
    v_add_f32 v131, 1.0, v131
    v_rcp_f32 v128, v128
    v_rcp_f32 v129, v129
    v_rcp_f32 v130, v130
    v_rcp_f32 v131, v131
    v_mul_f32 v128, v128, v144
    v_mul_f32 v129, v129, v145
    v_mul_f32 v130, v130, v146
    v_mul_f32 v131, v131, v147
    v_cvt_pk_bf16_f32 v144, v128, v129
    v_cvt_pk_bf16_f32 v145, v130, v131
    v_mul_f32 v132, s59, v132
    v_mul_f32 v133, s59, v133
    v_mul_f32 v134, s59, v134
    v_mul_f32 v135, s59, v135
    v_exp_f32 v132, v132
    v_exp_f32 v133, v133
    v_exp_f32 v134, v134
    v_exp_f32 v135, v135
    v_add_f32 v132, 1.0, v132
    v_add_f32 v133, 1.0, v133
    v_add_f32 v134, 1.0, v134
    v_add_f32 v135, 1.0, v135
    v_rcp_f32 v132, v132
    v_rcp_f32 v133, v133
    v_rcp_f32 v134, v134
    v_rcp_f32 v135, v135
    v_mul_f32 v132, v132, v148
    v_mul_f32 v133, v133, v149
    v_mul_f32 v134, v134, v150
    v_mul_f32 v135, v135, v151
    v_cvt_pk_bf16_f32 v146, v132, v133
    v_cvt_pk_bf16_f32 v147, v134, v135
    buffer_store_dwordx4 v[144:147], v11, s[32:35], s54 offen offset:2048 sc1
    v_mul_f32 v136, s59, v136
    v_mul_f32 v137, s59, v137
    v_mul_f32 v138, s59, v138
    v_mul_f32 v139, s59, v139
    v_exp_f32 v136, v136
    v_exp_f32 v137, v137
    v_exp_f32 v138, v138
    v_exp_f32 v139, v139
    v_add_f32 v136, 1.0, v136
    v_add_f32 v137, 1.0, v137
    v_add_f32 v138, 1.0, v138
    v_add_f32 v139, 1.0, v139
    v_rcp_f32 v136, v136
    v_rcp_f32 v137, v137
    v_rcp_f32 v138, v138
    s_barrier
    v_rcp_f32 v139, v139
    v_mul_f32 v136, v136, v152
    v_mul_f32 v137, v137, v153
    v_mul_f32 v138, v138, v154
    v_mul_f32 v139, v139, v155
    v_cvt_pk_bf16_f32 v148, v136, v137
    v_cvt_pk_bf16_f32 v149, v138, v139
    v_mul_f32 v140, s59, v140
    v_mul_f32 v141, s59, v141
    v_mul_f32 v142, s59, v142
    v_mul_f32 v143, s59, v143
    v_exp_f32 v140, v140
    v_exp_f32 v141, v141
    v_exp_f32 v142, v142
    v_exp_f32 v143, v143
    v_add_f32 v140, 1.0, v140
    v_add_f32 v141, 1.0, v141
    v_add_f32 v142, 1.0, v142
    v_add_f32 v143, 1.0, v143
    v_rcp_f32 v140, v140
    v_rcp_f32 v141, v141
    v_rcp_f32 v142, v142
    v_rcp_f32 v143, v143
    v_mul_f32 v140, v140, v156
    v_mul_f32 v141, v141, v157
    v_mul_f32 v142, v142, v158
    v_mul_f32 v143, v143, v159
    v_cvt_pk_bf16_f32 v150, v140, v141
    v_cvt_pk_bf16_f32 v151, v142, v143
    buffer_store_dwordx4 v[148:151], v11, s[32:35], s54 offen offset:3072 sc1
    s_setprio 1
    v_lshrrev_b32 v18, 7, v9
    v_bfe_u32 v19, v9, 4, 3
    v_lshrrev_b32 v20, 8, v9
    v_lshlrev_b32 v20, 1, v20
    v_xor_b32 v19, v19, v20
    v_mul_u32_u24 v18, 896, v18
    v_lshl_add_u32 v16, v19, 4, v18
    v_add_u32 v17, 6144, v16

    s_waitcnt vmcnt(2)
    s_mov_b64 exec, 1
    buffer_store_dwordx2 v[12:13], v14, s[32:35], 0 offen offset:128 sc0 sc1
    s_mov_b64 exec, -1
    s_waitcnt vmcnt(1)
    s_mov_b64 exec, 1
    buffer_store_dwordx2 v[12:13], v14, s[32:35], 0 offen offset:192 sc0 sc1
    s_mov_b64 exec, -1
    s_barrier
    s_add_u32 m0, s27, 147456
    s_add_u32 s68, s49, 2048
    buffer_load_dwordx4 v9, s[32:35], s68 offen sc1 lds
    buffer_load_dwordx4 v9, s[32:35], s68 offen offset:1024 sc1 lds
    s_add_u32 m0, s27, 151552
    s_add_u32 s68, s50, 2048
    buffer_load_dwordx4 v9, s[32:35], s68 offen sc1 lds
    buffer_load_dwordx4 v9, s[32:35], s68 offen offset:1024 sc1 lds
    s_load_dwordx16 s[0:15], s[72:73], 128 glc
    s_barrier
    s_waitcnt lgkmcnt(0)
    s_xor_b64 s[0:1], s[0:1], s[74:75]
    s_xor_b64 s[2:3], s[2:3], s[74:75]
    s_xor_b64 s[4:5], s[4:5], s[74:75]
    s_xor_b64 s[6:7], s[6:7], s[74:75]
    s_xor_b64 s[8:9], s[8:9], s[74:75]
    s_xor_b64 s[10:11], s[10:11], s[74:75]
    s_xor_b64 s[12:13], s[12:13], s[74:75]
    s_or_b64 s[0:1], s[0:1], s[2:3]
    s_or_b64 s[0:1], s[0:1], s[4:5]
    s_or_b64 s[0:1], s[0:1], s[6:7]
    s_or_b64 s[0:1], s[0:1], s[8:9]
    s_or_b64 s[0:1], s[0:1], s[10:11]
    s_or_b64 s[0:1], s[0:1], s[12:13]
    s_cbranch_scc1 L_gs2
    s_add_u32 m0, s27, 20480
    s_add_u32 s68, s44, 4096
    buffer_load_dwordx4 v9, s[32:35], s68 offen sc1 lds
    buffer_load_dwordx4 v9, s[32:35], s68 offen offset:1024 sc1 lds
    s_add_u32 m0, s27, 32768
    s_add_u32 s68, s45, 4096
    buffer_load_dwordx4 v9, s[32:35], s68 offen sc1 lds
    buffer_load_dwordx4 v9, s[32:35], s68 offen offset:1024 sc1 lds
    s_add_u32 m0, s27, 65536
    s_add_u32 s68, s46, 4096
    buffer_load_dwordx4 v9, s[32:35], s68 offen sc1 lds
    buffer_load_dwordx4 v9, s[32:35], s68 offen offset:1024 sc1 lds
    s_add_u32 m0, s27, 49152
    s_add_u32 s68, s47, 4096
    buffer_load_dwordx4 v9, s[32:35], s68 offen sc1 lds
    buffer_load_dwordx4 v9, s[32:35], s68 offen offset:1024 sc1 lds
    s_add_u32 m0, s27, 53248
    s_add_u32 s68, s48, 4096
    buffer_load_dwordx4 v9, s[32:35], s68 offen sc1 lds
    buffer_load_dwordx4 v9, s[32:35], s68 offen offset:1024 sc1 lds
    s_barrier
L_gf2:
    s_load_dwordx16 s[0:15], s[72:73], 192 glc
    s_add_u32 m0, s69, 69632
    s_mul_i32 s68, s47, 14
    s_add_u32 s68, s68, s66
    s_add_u32 s68, s68, 86016
    buffer_load_dwordx4 v16, s[28:31], s68 offen lds
    buffer_load_dwordx4 v17, s[28:31], s68 offen offset:1024 lds
    s_add_u32 m0, s27, 98304
    s_add_u32 s68, s49, 4096
    buffer_load_dwordx4 v9, s[32:35], s68 offen sc1 lds
    buffer_load_dwordx4 v9, s[32:35], s68 offen offset:1024 sc1 lds
    s_add_u32 m0, s69, 102400
    s_mul_i32 s68, s48, 14
    s_add_u32 s68, s68, s66
    s_add_u32 s68, s68, 86016
    buffer_load_dwordx4 v16, s[28:31], s68 offen lds
    buffer_load_dwordx4 v17, s[28:31], s68 offen offset:1024 lds
    s_waitcnt lgkmcnt(0)
    s_xor_b64 s[0:1], s[0:1], s[74:75]
    s_xor_b64 s[2:3], s[2:3], s[74:75]
    s_xor_b64 s[4:5], s[4:5], s[74:75]
    s_xor_b64 s[6:7], s[6:7], s[74:75]
    s_xor_b64 s[8:9], s[8:9], s[74:75]
    s_xor_b64 s[10:11], s[10:11], s[74:75]
    s_xor_b64 s[12:13], s[12:13], s[74:75]
    s_or_b64 s[0:1], s[0:1], s[2:3]
    s_or_b64 s[0:1], s[0:1], s[4:5]
    s_or_b64 s[0:1], s[0:1], s[6:7]
    s_or_b64 s[0:1], s[0:1], s[8:9]
    s_or_b64 s[0:1], s[0:1], s[10:11]
    s_or_b64 s[0:1], s[0:1], s[12:13]
    s_cbranch_scc1 L_gs3
    s_waitcnt vmcnt(12)
    s_barrier
L_gf3:
    s_add_u32 m0, s27, 131072
    s_add_u32 s68, s50, 4096
    buffer_load_dwordx4 v9, s[32:35], s68 offen sc1 lds
    buffer_load_dwordx4 v9, s[32:35], s68 offen offset:1024 sc1 lds
    s_add_u32 m0, s69, 114688
    s_mul_i32 s68, s49, 14
    s_add_u32 s68, s68, s66
    s_add_u32 s68, s68, 86016
    buffer_load_dwordx4 v16, s[28:31], s68 offen lds
    buffer_load_dwordx4 v17, s[28:31], s68 offen offset:1024 lds
    s_add_u32 m0, s27, 118784
    s_add_u32 s68, s44, 6144
    buffer_load_dwordx4 v9, s[32:35], s68 offen sc1 lds
    buffer_load_dwordx4 v9, s[32:35], s68 offen offset:1024 sc1 lds
    s_waitcnt vmcnt(12)
    s_barrier
    s_add_u32 m0, s69, 20480
    s_mul_i32 s68, s50, 14
    s_add_u32 s68, s68, s66
    s_add_u32 s68, s68, 86016
    buffer_load_dwordx4 v16, s[28:31], s68 offen lds
    buffer_load_dwordx4 v17, s[28:31], s68 offen offset:1024 lds
    s_add_u32 m0, s27, 135168
    s_add_u32 s68, s45, 6144
    buffer_load_dwordx4 v9, s[32:35], s68 offen sc1 lds
    buffer_load_dwordx4 v9, s[32:35], s68 offen offset:1024 sc1 lds
    s_add_u32 m0, s27, 147456
    s_add_u32 s68, s46, 6144
    buffer_load_dwordx4 v9, s[32:35], s68 offen sc1 lds
    buffer_load_dwordx4 v9, s[32:35], s68 offen offset:1024 sc1 lds
    s_add_u32 m0, s27, 151552
    s_add_u32 s68, s47, 6144
    buffer_load_dwordx4 v9, s[32:35], s68 offen sc1 lds
    buffer_load_dwordx4 v9, s[32:35], s68 offen offset:1024 sc1 lds
    s_waitcnt vmcnt(8)
    s_barrier
    s_mov_b32 m0, s27
    s_add_u32 s68, s48, 6144
    buffer_load_dwordx4 v9, s[32:35], s68 offen sc1 lds
    buffer_load_dwordx4 v9, s[32:35], s68 offen offset:1024 sc1 lds
    s_add_u32 m0, s27, 49152
    s_add_u32 s68, s49, 6144
    buffer_load_dwordx4 v9, s[32:35], s68 offen sc1 lds
    buffer_load_dwordx4 v9, s[32:35], s68 offen offset:1024 sc1 lds
    s_add_u32 m0, s27, 65536
    s_add_u32 s68, s50, 6144
    buffer_load_dwordx4 v9, s[32:35], s68 offen sc1 lds
    buffer_load_dwordx4 v9, s[32:35], s68 offen offset:1024 sc1 lds
    s_waitcnt vmcnt(10)
    s_barrier
    s_waitcnt vmcnt(8)
    s_barrier
    s_waitcnt vmcnt(6)
    s_barrier
    s_waitcnt vmcnt(4)
    s_barrier
    s_waitcnt vmcnt(0)
    s_barrier
    s_endpgm
L_slC0:
    s_mov_b32 s71, 0
    v_mov_b32 v0, 0
L_tgC0:
    buffer_load_dwordx2 v[12:13], v0, s[36:39], 0 offen sc1
    s_add_u32 s71, s71, 1
    s_waitcnt vmcnt(0)
    v_readfirstlane_b32 s74, v12
    v_readfirstlane_b32 s75, v13
    s_cmp_gt_u32 s71, 200000
    s_cbranch_scc1 L_ckC0
    s_cmp_eq_u32 s75, 0
    s_cbranch_scc0 L_ckC0
    s_sleep 4
    s_branch L_tgC0
L_gs2:
    s_barrier
    s_mov_b32 s71, 0
L_gp2:
    s_load_dwordx16 s[0:15], s[72:73], 128 glc
    s_add_u32 s71, s71, 1
    s_waitcnt lgkmcnt(0)
    s_cmp_gt_u32 s71, 200000
    s_cbranch_scc1 L_go2
    s_xor_b64 s[0:1], s[0:1], s[74:75]
    s_xor_b64 s[2:3], s[2:3], s[74:75]
    s_xor_b64 s[4:5], s[4:5], s[74:75]
    s_xor_b64 s[6:7], s[6:7], s[74:75]
    s_xor_b64 s[8:9], s[8:9], s[74:75]
    s_xor_b64 s[10:11], s[10:11], s[74:75]
    s_xor_b64 s[12:13], s[12:13], s[74:75]
    s_or_b64 s[0:1], s[0:1], s[2:3]
    s_or_b64 s[0:1], s[0:1], s[4:5]
    s_or_b64 s[0:1], s[0:1], s[6:7]
    s_or_b64 s[0:1], s[0:1], s[8:9]
    s_or_b64 s[0:1], s[0:1], s[10:11]
    s_or_b64 s[0:1], s[0:1], s[12:13]
    s_cbranch_scc1 L_gp2
L_go2:

    s_add_u32 m0, s27, 20480
    s_add_u32 s68, s44, 4096
    buffer_load_dwordx4 v9, s[32:35], s68 offen sc1 lds
    buffer_load_dwordx4 v9, s[32:35], s68 offen offset:1024 sc1 lds
    s_add_u32 m0, s27, 32768
    s_add_u32 s68, s45, 4096
    buffer_load_dwordx4 v9, s[32:35], s68 offen sc1 lds
    buffer_load_dwordx4 v9, s[32:35], s68 offen offset:1024 sc1 lds
    s_add_u32 m0, s27, 65536
    s_add_u32 s68, s46, 4096
    buffer_load_dwordx4 v9, s[32:35], s68 offen sc1 lds
    buffer_load_dwordx4 v9, s[32:35], s68 offen offset:1024 sc1 lds
    s_add_u32 m0, s27, 49152
    s_add_u32 s68, s47, 4096
    buffer_load_dwordx4 v9, s[32:35], s68 offen sc1 lds
    buffer_load_dwordx4 v9, s[32:35], s68 offen offset:1024 sc1 lds
    s_add_u32 m0, s27, 53248
    s_add_u32 s68, s48, 4096
    buffer_load_dwordx4 v9, s[32:35], s68 offen sc1 lds
    buffer_load_dwordx4 v9, s[32:35], s68 offen offset:1024 sc1 lds
    s_branch L_gf2
L_gs3:
    s_waitcnt vmcnt(12)
    s_barrier
    s_mov_b32 s71, 0
L_gp3:
    s_load_dwordx16 s[0:15], s[72:73], 192 glc
    s_add_u32 s71, s71, 1
    s_waitcnt lgkmcnt(0)
    s_cmp_gt_u32 s71, 200000
    s_cbranch_scc1 L_go3
    s_xor_b64 s[0:1], s[0:1], s[74:75]
    s_xor_b64 s[2:3], s[2:3], s[74:75]
    s_xor_b64 s[4:5], s[4:5], s[74:75]
    s_xor_b64 s[6:7], s[6:7], s[74:75]
    s_xor_b64 s[8:9], s[8:9], s[74:75]
    s_xor_b64 s[10:11], s[10:11], s[74:75]
    s_xor_b64 s[12:13], s[12:13], s[74:75]
    s_or_b64 s[0:1], s[0:1], s[2:3]
    s_or_b64 s[0:1], s[0:1], s[4:5]
    s_or_b64 s[0:1], s[0:1], s[6:7]
    s_or_b64 s[0:1], s[0:1], s[8:9]
    s_or_b64 s[0:1], s[0:1], s[10:11]
    s_or_b64 s[0:1], s[0:1], s[12:13]
    s_cbranch_scc1 L_gp3
L_go3:

    s_branch L_gf3

.section .rodata,"a"
.p2align 6
.amdhsa_kernel standalone__glu_gated_glu__prompt_kernel
  .amdhsa_next_free_vgpr 256
  .amdhsa_next_free_sgpr 102
  .amdhsa_accum_offset 256
  .amdhsa_group_segment_fixed_size 0
  .amdhsa_kernarg_size 56
  .amdhsa_user_sgpr_count 2
  .amdhsa_user_sgpr_kernarg_segment_ptr 1
  .amdhsa_system_sgpr_workgroup_id_x 1
.end_amdhsa_kernel
```
